```python
import torch

def _softmax(x, axis=-1):
    return torch.softmax(x, dim=axis)
def _gelu(x):
    return torch.nn.functional.gelu(x, approximate="tanh")
def _silu(x):
    return torch.nn.functional.silu(x)
def _sigmoid(x):
    return torch.sigmoid(x)
def _layernorm(x, axis=-1, eps=1e-5):
    m = x.mean(dim=axis, keepdim=True)
    v = x.var(dim=axis, keepdim=True, unbiased=False)
    return (x - m) / torch.sqrt(v + eps)
def _scatter_add(tgt, idx, src, axis=0):
    return tgt.clone().index_add_(axis, idx, src)
def _segment_sum(src, seg, n):
    out = torch.zeros((n,) + src.shape[1:], dtype=src.dtype)
    return out.index_add_(0, seg, src)
def _pad(x, pw):
    flat = tuple(v for pair in reversed(pw) for v in pair)
    return torch.nn.functional.pad(x, flat)

kernel_name = 'parallel_sum__grouped_kv_mqa__dense_activation_relu__prompt'

def setup_inputs():

    _w = (lambda a: (lambda t: t.to(torch.bfloat16) if t.is_floating_point() else t)(torch.as_tensor(a)))
    def _A_setup():
        B, S, D, H = 1, 2048, 512, 32
        Dh = D // H
        return {
            "x": _w((lambda *s: torch.randn(*s, dtype=torch.bfloat16) * 0.05)(B, S, D)),
            "wq": _w((lambda *s: torch.randn(*s, dtype=torch.bfloat16) * 0.2)(D, H * Dh)),
            "wk": _w((lambda *s: torch.randn(*s, dtype=torch.bfloat16) * 0.2)(D, Dh)),
            "wv": _w((lambda *s: torch.randn(*s, dtype=torch.bfloat16) * 0.1)(D, Dh)),
            "wo": _w((lambda *s: torch.randn(*s, dtype=torch.bfloat16) * 0.1)(H * Dh, D)),
        }
    _A_in = _A_setup()

    def _B_setup():
        B, S, D, Dff = 1, 2048, 512, 1792
        return {
            "x": _w((lambda *s: torch.randn(*s, dtype=torch.bfloat16) * 0.05)(B, S, D)),
            "w1": _w((lambda *s: torch.randn(*s, dtype=torch.bfloat16) * 0.1)(D, Dff)),
            "w2": _w((lambda *s: torch.randn(*s, dtype=torch.bfloat16) * 0.1)(Dff, D)),
        }
    _B_in = _B_setup()

    return {
        "A_x": _A_in["x"],
        "A_wq": _A_in["wq"],
        "A_wk": _A_in["wk"],
        "A_wv": _A_in["wv"],
        "A_wo": _A_in["wo"],
        "B_x": _B_in["x"],
        "B_w1": _B_in["w1"],
        "B_w2": _B_in["w2"],
    }

def reference(A_x, A_wq, A_wk, A_wv, A_wo, B_x, B_w1, B_w2):
    def _A_ref(x, wq, wk, wv, wo):
        B, S, D = x.shape
        H = 32
        Dh = D // H
        q = (lambda x, *d: x.permute(*d))((x @ wq).reshape(B, S, H, Dh), 0, 2, 1, 3)
        k = x @ wk
        v = x @ wv
        scores = torch.einsum("bhqd,bkd->bhqk", q, k) * (Dh ** -0.5)
        p = _softmax(scores, axis=-1)
        o = torch.einsum("bhqk,bkd->bhqd", p, v)
        return (lambda x, *d: x.permute(*d))(o, 0, 2, 1, 3).reshape(B, S, H * Dh) @ wo

    def _B_ref(x, w1, w2):
        h = torch.einsum("bsd,df->bsf", x, w1)
        zero = torch.zeros_like(h)
        h = torch.maximum(h, zero)
        return torch.einsum("bsf,fd->bsd", h, w2)

    x = A_x
    xn = _layernorm(x, axis=-1)
    return x + _A_ref(xn, A_wq, A_wk, A_wv, A_wo) + _B_ref(xn, B_w1, B_w2)
```

```asm
; @launch grid=(256,1,1) block=(512,1,1) lds=163840
.amdgcn_target "amdgcn-amd-amdhsa--gfx950"
.text
.globl parallel_sum__grouped_kv_mqa__dense_activation_relu__prompt_kernel
.p2align 8
.type parallel_sum__grouped_kv_mqa__dense_activation_relu__prompt_kernel,@function
parallel_sum__grouped_kv_mqa__dense_activation_relu__prompt_kernel:
    s_cmp_ge_u32 s2, 256
    s_cbranch_scc1 L_END
    s_load_dwordx16 s[4:19], s[0:1], 0
    v_lshrrev_b32 v16, 6, v0
    s_lshr_b32 s69, s2, 3
    s_mov_b32 s39, 0x20000
    v_readfirstlane_b32 s28, v16
    s_getpc_b64 s[36:37]
L_PC:
    s_mov_b32 s38, L_END-L_PC
    v_and_b32 v17, 1, v0
    v_lshl_add_u32 v16, v16, 1, v17
    v_lshlrev_b32 v16, 7, v16
    s_lshl_b32 s73, s69, 11
    buffer_load_dword v255, v16, s[36:39], s73 offen
    v_and_b32 v1, 63, v0
    s_and_b32 s72, s2, 7
    s_lshr_b32 s26, s72, 1
    s_and_b32 s60, s69, 7
    s_lshl3_add_u32 s26, s26, s60
    s_and_b32 s72, s72, 1
    s_lshr_b32 s74, s69, 3
    s_lshl2_add_u32 s27, s72, s74
    s_and_b32 s30, s28, 1
    s_lshr_b32 s31, s28, 1
    s_lshl2_add_u32 s3, s30, s31
    s_add_u32 s3, s3, s27
    s_and_b32 s3, s3, 7
    s_lshl_b32 s74, s3, 3
    v_lshrrev_b32 v22, 3, v1
    v_add_u32 v131, s74, v22
    v_lshlrev_b32 v16, 10, v131
    v_and_b32 v17, 7, v0
    v_lshl_add_u32 v2, v17, 4, v16
    v_lshlrev_b32 v3, 4, v1
    v_mul_u32_u24 v16, 1040, v131
    v_lshl_add_u32 v9, v17, 4, v16
    v_bfe_u32 v16, v1, 3, 1
    v_lshlrev_b32 v16, 2, v16
    v_xor_b32 v16, s27, v16
    v_lshl_add_u32 v243, v16, 3, v17
    v_mul_u32_u24 v16, 1040, v243
    v_lshrrev_b32 v18, 4, v1
    v_lshl_add_u32 v10, v18, 4, v16
    v_bfe_u32 v19, v1, 2, 2
    v_lshl_add_u32 v16, v18, 3, v19
    v_lshlrev_b32 v16, 5, v16
    v_and_b32 v20, 3, v1
    v_lshl_add_u32 v16, v20, 3, v16
    v_add_u32 v11, 146432, v16
    v_bfe_u32 v16, v1, 4, 1
    v_lshrrev_b32 v21, 1, v17
    v_xor_b32 v16, v16, v21
    v_lshlrev_b32 v21, 10, v22
    v_lshl_add_u32 v21, v16, 5, v21
    v_and_b32 v16, 1, v1
    v_lshl_add_u32 v21, v16, 4, v21
    s_lshl_b32 s73, s27, 7
    v_add_u32 v130, s73, v21
    s_lshl_b32 s72, s26, 16
    s_lshl_b32 s74, s60, 7
    s_add_u32 s44, s74, 0
    s_and_b32 s44, s44, 0x380
    s_or_b32 s44, s44, s72
    s_add_u32 s45, s74, 128
    s_and_b32 s45, s45, 0x380
    s_or_b32 s45, s45, s72
    s_add_u32 s46, s74, 256
    s_and_b32 s46, s46, 0x380
    s_or_b32 s46, s46, s72
    s_add_u32 s47, s74, 384
    s_and_b32 s47, s47, 0x380
    s_or_b32 s47, s47, s72
    s_add_u32 s48, s74, 512
    s_and_b32 s48, s48, 0x380
    s_or_b32 s48, s48, s72
    s_add_u32 s49, s74, 640
    s_and_b32 s49, s49, 0x380
    s_or_b32 s49, s49, s72
    s_add_u32 s50, s74, 768
    s_and_b32 s50, s50, 0x380
    s_or_b32 s50, s50, s72
    s_add_u32 s51, s74, 896
    s_and_b32 s51, s51, 0x380
    s_or_b32 s51, s51, s72
    s_mov_b32 s34, 0x200000
    s_mov_b32 s35, 0x20000
    s_movk_i32 s42, 16384
    s_mov_b32 s43, 0x20000
    s_and_b32 s73, s28, 3
    s_lshl2_add_u32 s73, s69, s73
    s_lshl_b32 s73, s73, 7
    s_lshl_b32 s76, s30, 13
    s_add_u32 s76, s76, 146432
    s_lshl2_add_u32 s77, s30, s60
    v_mov_b32 v22, 163072
    v_mov_b32 v23, 0
    s_lshl1_add_u32 s72, s26, s30
    s_lshl_b32 s79, s72, 15
    s_add_u32 s79, s79, 262144
    s_lshl2_add_u32 s74, s27, s31
    s_lshl_b32 s74, s74, 10
    s_add_u32 s22, s74, s79
    s_mov_b32 s58, 16777216
    s_mov_b32 s59, 0x20000
    v_mov_b32 v24, -1
    v_mov_b32 v25, -1
    v_mov_b32 v26, -1
    v_mov_b32 v27, -1
    s_bitcmp0_b32 s27, 2
    s_waitcnt lgkmcnt(0)
    s_cselect_b32 s40, s8, s10
    s_cselect_b32 s41, s9, s11
    s_mov_b32 s32, s4
    s_mov_b32 s33, s5
    buffer_load_dword v255, off, s[40:43], s73
    s_cmp_ge_u32 s28, 2
    s_cbranch_scc1 X_1
    buffer_load_dwordx4 v[32:35], v2, s[32:35], s44 offen
    buffer_load_dwordx4 v[36:39], v2, s[32:35], s45 offen
    buffer_load_dwordx4 v[40:43], v2, s[32:35], s46 offen
    buffer_load_dwordx4 v[44:47], v2, s[32:35], s47 offen
    buffer_load_dwordx4 v[48:51], v2, s[32:35], s48 offen
    buffer_load_dwordx4 v[52:55], v2, s[32:35], s49 offen
    buffer_load_dwordx4 v[56:59], v2, s[32:35], s50 offen
    buffer_load_dwordx4 v[60:63], v2, s[32:35], s51 offen
    s_add_u32 m0, s76, 0
    s_add_u32 s73, s77, 0
    s_and_b32 s73, s73, 7
    s_lshl_b32 s73, s73, 11
    buffer_load_dwordx4 v3, s[40:43], s73 offen offset:0 lds
    buffer_load_dwordx4 v3, s[40:43], s73 offen offset:1024 lds
    s_add_u32 m0, s76, 2048
    s_add_u32 s73, s77, 1
    s_and_b32 s73, s73, 7
    s_lshl_b32 s73, s73, 11
    buffer_load_dwordx4 v3, s[40:43], s73 offen offset:0 lds
    buffer_load_dwordx4 v3, s[40:43], s73 offen offset:1024 lds
    s_add_u32 m0, s76, 4096
    s_add_u32 s73, s77, 2
    s_and_b32 s73, s73, 7
    s_lshl_b32 s73, s73, 11
    buffer_load_dwordx4 v3, s[40:43], s73 offen offset:0 lds
    buffer_load_dwordx4 v3, s[40:43], s73 offen offset:1024 lds
    s_add_u32 m0, s76, 6144
    s_add_u32 s73, s77, 3
    s_and_b32 s73, s73, 7
    s_lshl_b32 s73, s73, 11
    buffer_load_dwordx4 v3, s[40:43], s73 offen offset:0 lds
    buffer_load_dwordx4 v3, s[40:43], s73 offen offset:1024 lds
    ds_write_b32 v22, v23
    ds_write_b32 v22, v23 offset:4
    s_waitcnt lgkmcnt(0)
    s_barrier
    s_branch X_2
X_1:
    s_barrier
    buffer_load_dwordx4 v[32:35], v2, s[32:35], s44 offen
    buffer_load_dwordx4 v[36:39], v2, s[32:35], s45 offen
    buffer_load_dwordx4 v[40:43], v2, s[32:35], s46 offen
    buffer_load_dwordx4 v[44:47], v2, s[32:35], s47 offen
    buffer_load_dwordx4 v[48:51], v2, s[32:35], s48 offen
    buffer_load_dwordx4 v[52:55], v2, s[32:35], s49 offen
    buffer_load_dwordx4 v[56:59], v2, s[32:35], s50 offen
    buffer_load_dwordx4 v[60:63], v2, s[32:35], s51 offen
    s_mov_b32 s36, s6
    s_mov_b32 s37, s7
    s_cmp_eq_u32 s28, 7
    s_cselect_b32 s38, 0x80000, 0
    s_lshl_b32 s72, s60, 16
    s_lshl_b32 s73, s27, 7
    s_add_u32 s72, s72, s73
    v_lshlrev_b32 v16, 10, v1
    buffer_load_dword v255, v16, s[36:39], s72 offen
X_2:
    s_load_dwordx2 s[20:21], s[0:1], 64
    s_load_dwordx2 s[24:25], s[0:1], 80
    s_mov_b32 s8, s6
    s_mov_b32 s9, s7
    s_mov_b32 s10, 0x80000
    s_mov_b32 s11, 0x20000
    s_mov_b32 s36, s16
    s_mov_b32 s37, s17
    s_mov_b32 s38, 1835008
    s_mov_b32 s46, 16777216
    s_mov_b32 s47, 0x20000
    s_mov_b32 s48, s18
    s_mov_b32 s49, s19
    s_mov_b32 s50, 1835008
    s_mov_b32 s51, 0x20000
    s_mov_b32 s52, s12
    s_mov_b32 s53, s13
    s_mov_b32 s54, 0x80000
    s_mov_b32 s55, 0x20000
    s_mov_b32 s66, 0x3f803f80
    s_mov_b32 s67, 0x00003f80
    s_mov_b32 s68, 0x3f800000
    s_mov_b32 s70, 0x0000ffff
    s_mov_b32 s71, 0x0000ffff
    s_lshl_b32 s83, s28, 10
    s_add_u32 s82, s83, 65536
    s_add_u32 s83, s83, 66560
    s_mul_i32 s61, s60, 229376
    s_min_u32 s75, s28, 6
    s_lshl_b32 s62, s75, 10
    s_add_u32 s72, s28, 8
    s_cmp_lt_u32 s28, 6
    s_cselect_b32 s72, s72, 7
    s_lshl_b32 s63, s72, 10
    s_mul_i32 s73, s27, 448
    s_movk_i32 s74, 2341
    v_lshl_add_u32 v16, s75, 6, v1
    v_mul_lo_u32 v17, v16, s74
    v_lshrrev_b32 v17, 16, v17
    v_mul_u32_u24 v21, 28, v17
    v_sub_u32 v16, v16, v21
    v_mul_u32_u24 v17, 3584, v17
    v_lshl_add_u32 v16, v16, 4, v17
    v_add_u32 v7, s73, v16
    v_lshl_add_u32 v16, s72, 6, v1
    v_mul_lo_u32 v17, v16, s74
    v_lshrrev_b32 v17, 16, v17
    v_mul_u32_u24 v21, 28, v17
    v_sub_u32 v16, v16, v21
    v_mul_u32_u24 v17, 3584, v17
    v_lshl_add_u32 v16, v16, 4, v17
    v_add_u32 v8, s73, v16
    v_lshrrev_b32 v21, 5, v1
    v_bfe_u32 v22, v1, 4, 1
    v_lshl_add_u32 v16, v21, 3, v19
    v_mul_u32_u24 v16, 448, v16
    v_lshl_add_u32 v16, v22, 5, v16
    v_lshl_add_u32 v16, v20, 3, v16
    s_lshl_b32 s72, s31, 7
    s_add_u32 s72, s72, 99328
    v_add_u32 v5, s72, v16
    s_cmp_lt_u32 s31, 3
    s_cselect_b32 s72, 64, 0
    v_add_u32 v6, s72, v5
    v_and_b32 v16, 31, v1
    s_lshl_b32 s72, s30, 5
    v_add_u32 v17, s72, v16
    v_mul_u32_u24 v17, 1040, v17
    v_lshl_add_u32 v4, v21, 4, v17
    v_lshlrev_b32 v16, 10, v16
    v_lshl_add_u32 v128, v21, 4, v16
    v_and_b32 v23, 15, v1
    v_add_u32 v17, s72, v23
    v_mul_u32_u24 v17, 1040, v17
    v_lshl_add_u32 v241, v18, 8, v17
    v_xor_b32 v242, 64, v130
    v_bfe_u32 v16, v1, 3, 1
    v_lshl_or_b32 v16, v22, 1, v16
    v_xor_b32 v16, s31, v16
    v_lshlrev_b32 v16, 5, v16
    v_lshl_add_u32 v16, v18, 14, v16
    v_lshl_add_u32 v16, v19, 7, v16
    v_lshl_add_u32 v16, v20, 3, v16
    v_add_u32 v240, 66560, v16
    v_bfe_u32 v16, v1, 3, 2
    v_lshlrev_b32 v17, 9, v16
    v_lshrrev_b32 v16, 1, v16
    v_xor_b32 v16, v16, v21
    v_lshl_add_u32 v17, v16, 7, v17
    v_and_b32 v16, 7, v1
    v_lshl_add_u32 v17, v16, 4, v17
    v_add_u32 v120, 66560, v17
    v_lshlrev_b32 v17, 9, v21
    v_lshl_add_u32 v17, v23, 4, v17
    v_add_u32 v121, 66816, v17
    v_mov_b32 v122, 0xdddddddd
    v_lshrrev_b32 v16, 2, v1
    v_lshlrev_b32 v16, 10, v16
    v_lshl_add_u32 v127, v20, 7, v16
    v_lshl_add_u32 v16, v20, 4, v16
    s_lshl_b32 s72, s27, 7
    s_lshl_b32 s73, s30, 6
    s_add_u32 s72, s72, s73
    v_add_u32 v123, s72, v16
    v_lshlrev_b32 v16, 6, v19
    v_lshl_add_u32 v16, v22, 5, v16
    v_lshl_add_u32 v16, v20, 3, v16
    v_lshl_add_u32 v16, v21, 8, v16
    s_lshl_b32 s72, s31, 11
    v_add_u32 v124, s72, v16
    v_add_u32 v125, 66560, v124
    v_add_u32 v126, 99328, v124
    s_lshl_b32 s81, s30, 10
    s_add_u32 s81, s81, s72
    s_lshl1_add_u32 s72, s26, s30
    s_mul_i32 s74, s72, 112
    s_mul_i32 s73, s31, 28
    s_add_u32 s78, s74, s73
    s_lshl_b32 s78, s78, 10
    s_add_u32 s78, s78, 3145728
    s_mul_i32 s73, s27, 14
    s_add_u32 s74, s74, s73
    s_lshl2_add_u32 s74, s31, s74
    s_lshl_b32 s64, s74, 10
    s_add_u32 s64, s64, 3145728
    s_cmp_lt_u32 s31, 3
    s_cselect_b32 s65, s64, 0x7f000000
    s_lshl_b32 s15, s72, 15
    s_lshl_b32 s73, s27, 7
    s_add_u32 s15, s15, s73
    s_lshl_b32 s73, s31, 5
    s_add_u32 s15, s15, s73
    s_mul_i32 s14, s31, 458752
    s_lshl_b32 s72, s30, 11
    v_add_u32 v129, s72, v3
    s_waitcnt lgkmcnt(0)
    s_load_dword s29, s[24:25], 0
    s_mov_b32 s44, s24
    s_mov_b32 s45, s25
    s_cmp_ge_u32 s28, 2
    s_cbranch_scc1 LB_3
    s_mul_i32 s73, s27, 448
    s_movk_i32 s74, 2341
    v_add_u32 v16, 0, v1
    v_mul_lo_u32 v17, v16, s74
    v_lshrrev_b32 v17, 16, v17
    v_mul_u32_u24 v21, 28, v17
    v_sub_u32 v16, v16, v21
    v_mul_u32_u24 v17, 3584, v17
    v_lshl_add_u32 v16, v16, 4, v17
    s_sub_u32 s75, s73, 0
    v_add_u32 v64, s75, v16
    v_add_u32 v16, 64, v1
    v_mul_lo_u32 v17, v16, s74
    v_lshrrev_b32 v17, 16, v17
    v_mul_u32_u24 v21, 28, v17
    v_sub_u32 v16, v16, v21
    v_mul_u32_u24 v17, 3584, v17
    v_lshl_add_u32 v16, v16, 4, v17
    s_sub_u32 s75, s73, 1024
    v_add_u32 v65, s75, v16
    v_add_u32 v16, 128, v1
    v_mul_lo_u32 v17, v16, s74
    v_lshrrev_b32 v17, 16, v17
    v_mul_u32_u24 v21, 28, v17
    v_sub_u32 v16, v16, v21
    v_mul_u32_u24 v17, 3584, v17
    v_lshl_add_u32 v16, v16, 4, v17
    s_sub_u32 s75, s73, 2048
    v_add_u32 v66, s75, v16
    v_add_u32 v16, 192, v1
    v_mul_lo_u32 v17, v16, s74
    v_lshrrev_b32 v17, 16, v17
    v_mul_u32_u24 v21, 28, v17
    v_sub_u32 v16, v16, v21
    v_mul_u32_u24 v17, 3584, v17
    v_lshl_add_u32 v16, v16, 4, v17
    s_sub_u32 s75, s73, 3072
    v_add_u32 v67, s75, v16
    v_add_u32 v16, 256, v1
    v_mul_lo_u32 v17, v16, s74
    v_lshrrev_b32 v17, 16, v17
    v_mul_u32_u24 v21, 28, v17
    v_sub_u32 v16, v16, v21
    v_mul_u32_u24 v17, 3584, v17
    v_lshl_add_u32 v16, v16, 4, v17
    s_sub_u32 s75, s73, 0
    v_add_u32 v68, s75, v16
    v_add_u32 v16, 320, v1
    v_mul_lo_u32 v17, v16, s74
    v_lshrrev_b32 v17, 16, v17
    v_mul_u32_u24 v21, 28, v17
    v_sub_u32 v16, v16, v21
    v_mul_u32_u24 v17, 3584, v17
    v_lshl_add_u32 v16, v16, 4, v17
    s_sub_u32 s75, s73, 1024
    v_add_u32 v69, s75, v16
    v_add_u32 v16, 384, v1
    v_mul_lo_u32 v17, v16, s74
    v_lshrrev_b32 v17, 16, v17
    v_mul_u32_u24 v21, 28, v17
    v_sub_u32 v16, v16, v21
    v_mul_u32_u24 v17, 3584, v17
    v_lshl_add_u32 v16, v16, 4, v17
    s_sub_u32 s75, s73, 2048
    v_add_u32 v70, s75, v16
    v_add_u32 v72, 0, v130
    v_add_u32 v80, 0, v242
    v_add_u32 v73, 7168, v130
    v_add_u32 v81, 7168, v242
    v_add_u32 v74, 14336, v130
    v_add_u32 v82, 14336, v242
    v_add_u32 v75, 21504, v130
    v_add_u32 v83, 21504, v242
    v_add_u32 v76, 32768, v130
    v_add_u32 v84, 32768, v242
    v_add_u32 v77, 39936, v130
    v_add_u32 v85, 39936, v242
    v_add_u32 v78, 47104, v130
    v_add_u32 v86, 47104, v242
    v_add_u32 v79, 54272, v130
    v_add_u32 v87, 54272, v242
    v_lshlrev_b32 v96, 2, v243
    v_add_u32 v96, 162816, v96
    v_lshrrev_b32 v19, 4, v1
    v_lshrrev_b32 v21, 1, v19
    v_lshlrev_b32 v97, 2, v21
    v_xor_b32 v97, s27, v97
    v_and_b32 v98, 15, v1
    v_lshlrev_b32 v98, 4, v98
    v_lshl_add_u32 v98, v97, 9, v98
    v_and_b32 v28, 1, v19
    v_lshl_add_u32 v98, v28, 3, v98
    v_lshlrev_b32 v97, 5, v97
    v_lshl_add_u32 v97, v28, 4, v97
    v_add_u32 v97, 162816, v97
    s_lshr_b32 s73, s27, 1
    v_xor_b32 v99, s73, v19
    v_and_b32 v99, 1, v99
    v_lshlrev_b32 v99, 7, v99
    v_lshl_add_u32 v99, v21, 3, v99
    v_lshrrev_b32 v21, 3, v243
    v_lshl_add_u32 v99, v21, 9, v99
    v_and_b32 v21, 7, v1
    v_lshl_add_u32 v99, v21, 4, v99
    v_mov_b32 v12, 0
    v_mov_b32 v13, 0
    s_waitcnt vmcnt(12)
    v_dot2_f32_bf16 v12, v32, s66, v12
    v_dot2_f32_bf16 v13, v33, s66, v13
    v_dot2_f32_bf16 v12, v34, s66, v12
    v_dot2_f32_bf16 v13, v35, s66, v13
    v_dot2_f32_bf16 v12, v36, s66, v12
    v_dot2_f32_bf16 v13, v37, s66, v13
    v_dot2_f32_bf16 v12, v38, s66, v12
    v_dot2_f32_bf16 v13, v39, s66, v13
    v_dot2_f32_bf16 v12, v40, s66, v12
    v_dot2_f32_bf16 v13, v41, s66, v13
    v_dot2_f32_bf16 v12, v42, s66, v12
    v_dot2_f32_bf16 v13, v43, s66, v13
    v_dot2_f32_bf16 v12, v44, s66, v12
    v_dot2_f32_bf16 v13, v45, s66, v13
    v_dot2_f32_bf16 v12, v46, s66, v12
    v_dot2_f32_bf16 v13, v47, s66, v13
    s_waitcnt vmcnt(8)
    v_dot2_f32_bf16 v12, v48, s66, v12
    v_dot2_f32_bf16 v13, v49, s66, v13
    v_dot2_f32_bf16 v12, v50, s66, v12
    v_dot2_f32_bf16 v13, v51, s66, v13
    v_dot2_f32_bf16 v12, v52, s66, v12
    v_dot2_f32_bf16 v13, v53, s66, v13
    v_dot2_f32_bf16 v12, v54, s66, v12
    v_dot2_f32_bf16 v13, v55, s66, v13
    v_dot2_f32_bf16 v12, v56, s66, v12
    v_dot2_f32_bf16 v13, v57, s66, v13
    v_dot2_f32_bf16 v12, v58, s66, v12
    v_dot2_f32_bf16 v13, v59, s66, v13
    v_dot2_f32_bf16 v12, v60, s66, v12
    v_dot2_f32_bf16 v13, v61, s66, v13
    v_dot2_f32_bf16 v12, v62, s66, v12
    v_dot2_f32_bf16 v13, v63, s66, v13
    v_mov_b32 v24, 0
    v_mov_b32 v25, 0
    v_mov_b32 v26, 0
    v_mov_b32 v27, 0
    v_add_f32 v12, v12, v13
    s_nop 1
    v_add_f32_dpp v12, v12, v12 quad_perm:[1,0,3,2] row_mask:0xf bank_mask:0xf
    s_nop 1
    v_add_f32_dpp v12, v12, v12 quad_perm:[2,3,0,1] row_mask:0xf bank_mask:0xf
    s_nop 1
    v_add_f32_dpp v12, v12, v12 row_half_mirror row_mask:0xf bank_mask:0xf
    v_mul_f32 v12, 0x3b000000, v12
    v_cvt_pk_bf16_f32 v14, v12, v12
    v_and_b32 v14, 0xffff0000, v14
    v_sub_f32 v15, v12, v14
    v_xor_b32 v14, 0x80000000, v14
    v_dot2_f32_bf16 v16, v32, s67, v14
    v_dot2_f32_bf16 v17, v32, s68, v14
    v_dot2_f32_bf16 v18, v33, s67, v14
    v_dot2_f32_bf16 v19, v33, s68, v14
    v_dot2_f32_bf16 v20, v34, s67, v14
    v_dot2_f32_bf16 v21, v34, s68, v14
    v_dot2_f32_bf16 v22, v35, s67, v14
    v_dot2_f32_bf16 v23, v35, s68, v14
    v_pk_fma_f32 v[24:25], v[16:17], v[16:17], v[24:25]
    v_cvt_pk_bf16_f32 v32, v16, v17
    v_pk_fma_f32 v[26:27], v[18:19], v[18:19], v[26:27]
    v_cvt_pk_bf16_f32 v33, v18, v19
    v_pk_fma_f32 v[24:25], v[20:21], v[20:21], v[24:25]
    v_cvt_pk_bf16_f32 v34, v20, v21
    v_pk_fma_f32 v[26:27], v[22:23], v[22:23], v[26:27]
    v_cvt_pk_bf16_f32 v35, v22, v23
    ds_write_b128 v9, v[32:35] offset:0
    v_dot2_f32_bf16 v16, v36, s67, v14
    v_dot2_f32_bf16 v17, v36, s68, v14
    v_dot2_f32_bf16 v18, v37, s67, v14
    v_dot2_f32_bf16 v19, v37, s68, v14
    v_dot2_f32_bf16 v20, v38, s67, v14
    v_dot2_f32_bf16 v21, v38, s68, v14
    v_dot2_f32_bf16 v22, v39, s67, v14
    v_dot2_f32_bf16 v23, v39, s68, v14
    v_pk_fma_f32 v[24:25], v[16:17], v[16:17], v[24:25]
    v_cvt_pk_bf16_f32 v36, v16, v17
    v_pk_fma_f32 v[26:27], v[18:19], v[18:19], v[26:27]
    v_cvt_pk_bf16_f32 v37, v18, v19
    v_pk_fma_f32 v[24:25], v[20:21], v[20:21], v[24:25]
    v_cvt_pk_bf16_f32 v38, v20, v21
    v_pk_fma_f32 v[26:27], v[22:23], v[22:23], v[26:27]
    v_cvt_pk_bf16_f32 v39, v22, v23
    ds_write_b128 v9, v[36:39] offset:128
    v_dot2_f32_bf16 v16, v40, s67, v14
    v_dot2_f32_bf16 v17, v40, s68, v14
    v_dot2_f32_bf16 v18, v41, s67, v14
    v_dot2_f32_bf16 v19, v41, s68, v14
    v_dot2_f32_bf16 v20, v42, s67, v14
    v_dot2_f32_bf16 v21, v42, s68, v14
    v_dot2_f32_bf16 v22, v43, s67, v14
    v_dot2_f32_bf16 v23, v43, s68, v14
    v_pk_fma_f32 v[24:25], v[16:17], v[16:17], v[24:25]
    v_cvt_pk_bf16_f32 v40, v16, v17
    v_pk_fma_f32 v[26:27], v[18:19], v[18:19], v[26:27]
    v_cvt_pk_bf16_f32 v41, v18, v19
    v_pk_fma_f32 v[24:25], v[20:21], v[20:21], v[24:25]
    v_cvt_pk_bf16_f32 v42, v20, v21
    v_pk_fma_f32 v[26:27], v[22:23], v[22:23], v[26:27]
    v_cvt_pk_bf16_f32 v43, v22, v23
    ds_write_b128 v9, v[40:43] offset:256
    v_dot2_f32_bf16 v16, v44, s67, v14
    v_dot2_f32_bf16 v17, v44, s68, v14
    v_dot2_f32_bf16 v18, v45, s67, v14
    v_dot2_f32_bf16 v19, v45, s68, v14
    v_dot2_f32_bf16 v20, v46, s67, v14
    v_dot2_f32_bf16 v21, v46, s68, v14
    v_dot2_f32_bf16 v22, v47, s67, v14
    v_dot2_f32_bf16 v23, v47, s68, v14
    v_pk_fma_f32 v[24:25], v[16:17], v[16:17], v[24:25]
    v_cvt_pk_bf16_f32 v44, v16, v17
    v_pk_fma_f32 v[26:27], v[18:19], v[18:19], v[26:27]
    v_cvt_pk_bf16_f32 v45, v18, v19
    v_pk_fma_f32 v[24:25], v[20:21], v[20:21], v[24:25]
    v_cvt_pk_bf16_f32 v46, v20, v21
    v_pk_fma_f32 v[26:27], v[22:23], v[22:23], v[26:27]
    v_cvt_pk_bf16_f32 v47, v22, v23
    ds_write_b128 v9, v[44:47] offset:384
    v_dot2_f32_bf16 v16, v48, s67, v14
    v_dot2_f32_bf16 v17, v48, s68, v14
    v_dot2_f32_bf16 v18, v49, s67, v14
    v_dot2_f32_bf16 v19, v49, s68, v14
    v_dot2_f32_bf16 v20, v50, s67, v14
    v_dot2_f32_bf16 v21, v50, s68, v14
    v_dot2_f32_bf16 v22, v51, s67, v14
    v_dot2_f32_bf16 v23, v51, s68, v14
    v_pk_fma_f32 v[24:25], v[16:17], v[16:17], v[24:25]
    v_cvt_pk_bf16_f32 v48, v16, v17
    v_pk_fma_f32 v[26:27], v[18:19], v[18:19], v[26:27]
    v_cvt_pk_bf16_f32 v49, v18, v19
    v_pk_fma_f32 v[24:25], v[20:21], v[20:21], v[24:25]
    v_cvt_pk_bf16_f32 v50, v20, v21
    v_pk_fma_f32 v[26:27], v[22:23], v[22:23], v[26:27]
    v_cvt_pk_bf16_f32 v51, v22, v23
    ds_write_b128 v9, v[48:51] offset:512
    v_dot2_f32_bf16 v16, v52, s67, v14
    v_dot2_f32_bf16 v17, v52, s68, v14
    v_dot2_f32_bf16 v18, v53, s67, v14
    v_dot2_f32_bf16 v19, v53, s68, v14
    v_dot2_f32_bf16 v20, v54, s67, v14
    v_dot2_f32_bf16 v21, v54, s68, v14
    v_dot2_f32_bf16 v22, v55, s67, v14
    v_dot2_f32_bf16 v23, v55, s68, v14
    v_pk_fma_f32 v[24:25], v[16:17], v[16:17], v[24:25]
    v_cvt_pk_bf16_f32 v52, v16, v17
    v_pk_fma_f32 v[26:27], v[18:19], v[18:19], v[26:27]
    v_cvt_pk_bf16_f32 v53, v18, v19
    v_pk_fma_f32 v[24:25], v[20:21], v[20:21], v[24:25]
    v_cvt_pk_bf16_f32 v54, v20, v21
    v_pk_fma_f32 v[26:27], v[22:23], v[22:23], v[26:27]
    v_cvt_pk_bf16_f32 v55, v22, v23
    ds_write_b128 v9, v[52:55] offset:640
    v_dot2_f32_bf16 v16, v56, s67, v14
    v_dot2_f32_bf16 v17, v56, s68, v14
    v_dot2_f32_bf16 v18, v57, s67, v14
    v_dot2_f32_bf16 v19, v57, s68, v14
    v_dot2_f32_bf16 v20, v58, s67, v14
    v_dot2_f32_bf16 v21, v58, s68, v14
    v_dot2_f32_bf16 v22, v59, s67, v14
    v_dot2_f32_bf16 v23, v59, s68, v14
    v_pk_fma_f32 v[24:25], v[16:17], v[16:17], v[24:25]
    v_cvt_pk_bf16_f32 v56, v16, v17
    v_pk_fma_f32 v[26:27], v[18:19], v[18:19], v[26:27]
    v_cvt_pk_bf16_f32 v57, v18, v19
    v_pk_fma_f32 v[24:25], v[20:21], v[20:21], v[24:25]
    v_cvt_pk_bf16_f32 v58, v20, v21
    v_pk_fma_f32 v[26:27], v[22:23], v[22:23], v[26:27]
    v_cvt_pk_bf16_f32 v59, v22, v23
    ds_write_b128 v9, v[56:59] offset:768
    v_dot2_f32_bf16 v16, v60, s67, v14
    v_dot2_f32_bf16 v17, v60, s68, v14
    v_dot2_f32_bf16 v18, v61, s67, v14
    v_dot2_f32_bf16 v19, v61, s68, v14
    v_dot2_f32_bf16 v20, v62, s67, v14
    v_dot2_f32_bf16 v21, v62, s68, v14
    v_dot2_f32_bf16 v22, v63, s67, v14
    v_dot2_f32_bf16 v23, v63, s68, v14
    v_pk_fma_f32 v[24:25], v[16:17], v[16:17], v[24:25]
    v_cvt_pk_bf16_f32 v60, v16, v17
    v_pk_fma_f32 v[26:27], v[18:19], v[18:19], v[26:27]
    v_cvt_pk_bf16_f32 v61, v18, v19
    v_pk_fma_f32 v[24:25], v[20:21], v[20:21], v[24:25]
    v_cvt_pk_bf16_f32 v62, v20, v21
    v_pk_fma_f32 v[26:27], v[22:23], v[22:23], v[26:27]
    v_cvt_pk_bf16_f32 v63, v22, v23
    ds_write_b128 v9, v[60:63] offset:896
    v_pk_add_f32 v[24:25], v[24:25], v[26:27]
    v_add_f32 v12, v24, v25
    s_nop 1
    v_add_f32_dpp v12, v12, v12 quad_perm:[1,0,3,2] row_mask:0xf bank_mask:0xf
    s_nop 1
    v_add_f32_dpp v12, v12, v12 quad_perm:[2,3,0,1] row_mask:0xf bank_mask:0xf
    s_nop 1
    v_add_f32_dpp v12, v12, v12 row_half_mirror row_mask:0xf bank_mask:0xf
    v_mul_f32 v12, 0x3b000000, v12
    v_fma_f32 v12, -v15, v15, v12
    v_max_f32 v12, 0, v12
    v_cvt_pk_bf16_f32 v12, v12, v12
    v_and_b32 v12, 0xffff0000, v12
    v_add_f32 v12, 0x3727c5ac, v12
    v_cvt_pk_bf16_f32 v12, v12, v12
    v_and_b32 v12, 0xffff0000, v12
    v_sqrt_f32 v12, v12
    v_lshlrev_b32 v16, 2, v131
    v_cvt_pk_bf16_f32 v12, v12, v12
    v_and_b32 v12, 0xffff0000, v12
    v_rcp_f32 v13, v12
    v_add_u32 v16, 162816, v16
    ds_write_b32 v16, v13
    v_mov_b32 v22, 163072
    s_cmp_eq_u32 s28, 0
    s_cbranch_scc1 KW_5
    v_mov_b32 v23, 1
    s_waitcnt vmcnt(0) lgkmcnt(0)
    ds_write_b32 v22, v23
    s_add_u32 s72, s60, 0
    s_and_b32 s72, s72, 7
    s_lshl_b32 s72, s72, 16
    s_mov_b32 m0, 66560
    s_nop 0
    buffer_load_dwordx4 v72, s[8:11], s72 offen offset:0 lds
    buffer_load_dwordx4 v73, s[8:11], s72 offen offset:1024 lds
    buffer_load_dwordx4 v74, s[8:11], s72 offen offset:2048 lds
    buffer_load_dwordx4 v75, s[8:11], s72 offen offset:3072 lds
    s_mov_b32 m0, 70656
    s_nop 0
    buffer_load_dwordx4 v76, s[8:11], s72 offen offset:0 lds
    buffer_load_dwordx4 v77, s[8:11], s72 offen offset:1024 lds
    buffer_load_dwordx4 v78, s[8:11], s72 offen offset:2048 lds
    buffer_load_dwordx4 v79, s[8:11], s72 offen offset:3072 lds
    s_add_u32 s72, s60, 1
    s_and_b32 s72, s72, 7
    s_lshl_b32 s72, s72, 16
    s_mov_b32 m0, 74752
    s_nop 0
    buffer_load_dwordx4 v72, s[8:11], s72 offen offset:0 lds
    buffer_load_dwordx4 v73, s[8:11], s72 offen offset:1024 lds
    buffer_load_dwordx4 v74, s[8:11], s72 offen offset:2048 lds
    buffer_load_dwordx4 v75, s[8:11], s72 offen offset:3072 lds
    s_mov_b32 m0, 78848
    s_nop 0
    buffer_load_dwordx4 v76, s[8:11], s72 offen offset:0 lds
    buffer_load_dwordx4 v77, s[8:11], s72 offen offset:1024 lds
    buffer_load_dwordx4 v78, s[8:11], s72 offen offset:2048 lds
    buffer_load_dwordx4 v79, s[8:11], s72 offen offset:3072 lds
    s_add_u32 s72, s60, 2
    s_and_b32 s72, s72, 7
    s_lshl_b32 s72, s72, 16
    s_mov_b32 m0, 82944
    s_nop 0
    buffer_load_dwordx4 v80, s[8:11], s72 offen offset:0 lds
    buffer_load_dwordx4 v81, s[8:11], s72 offen offset:1024 lds
    buffer_load_dwordx4 v82, s[8:11], s72 offen offset:2048 lds
    buffer_load_dwordx4 v83, s[8:11], s72 offen offset:3072 lds
    s_mov_b32 m0, 87040
    s_nop 0
    buffer_load_dwordx4 v84, s[8:11], s72 offen offset:0 lds
    buffer_load_dwordx4 v85, s[8:11], s72 offen offset:1024 lds
    buffer_load_dwordx4 v86, s[8:11], s72 offen offset:2048 lds
    buffer_load_dwordx4 v87, s[8:11], s72 offen offset:3072 lds
    s_add_u32 s72, s60, 3
    s_and_b32 s72, s72, 7
    s_lshl_b32 s72, s72, 16
    s_mov_b32 m0, 91136
    s_nop 0
    buffer_load_dwordx4 v80, s[8:11], s72 offen offset:0 lds
    buffer_load_dwordx4 v81, s[8:11], s72 offen offset:1024 lds
    buffer_load_dwordx4 v82, s[8:11], s72 offen offset:2048 lds
    buffer_load_dwordx4 v83, s[8:11], s72 offen offset:3072 lds
    s_mov_b32 m0, 95232
    s_nop 0
    buffer_load_dwordx4 v84, s[8:11], s72 offen offset:0 lds
    buffer_load_dwordx4 v85, s[8:11], s72 offen offset:1024 lds
    buffer_load_dwordx4 v86, s[8:11], s72 offen offset:2048 lds
    buffer_load_dwordx4 v87, s[8:11], s72 offen offset:3072 lds
    s_add_u32 s72, s60, 4
    s_and_b32 s72, s72, 7
    s_lshl_b32 s72, s72, 16
    s_mov_b32 m0, 99328
    s_nop 0
    buffer_load_dwordx4 v72, s[8:11], s72 offen offset:0 lds
    buffer_load_dwordx4 v73, s[8:11], s72 offen offset:1024 lds
    buffer_load_dwordx4 v74, s[8:11], s72 offen offset:2048 lds
    buffer_load_dwordx4 v75, s[8:11], s72 offen offset:3072 lds
    s_mov_b32 m0, 103424
    s_nop 0
    buffer_load_dwordx4 v76, s[8:11], s72 offen offset:0 lds
    buffer_load_dwordx4 v77, s[8:11], s72 offen offset:1024 lds
    buffer_load_dwordx4 v78, s[8:11], s72 offen offset:2048 lds
    buffer_load_dwordx4 v79, s[8:11], s72 offen offset:3072 lds
    s_add_u32 s72, s60, 5
    s_and_b32 s72, s72, 7
    s_lshl_b32 s72, s72, 16
    s_mov_b32 m0, 107520
    s_nop 0
    buffer_load_dwordx4 v72, s[8:11], s72 offen offset:0 lds
    buffer_load_dwordx4 v73, s[8:11], s72 offen offset:1024 lds
    buffer_load_dwordx4 v74, s[8:11], s72 offen offset:2048 lds
    buffer_load_dwordx4 v75, s[8:11], s72 offen offset:3072 lds
    s_mov_b32 m0, 111616
    s_nop 0
    buffer_load_dwordx4 v76, s[8:11], s72 offen offset:0 lds
    buffer_load_dwordx4 v77, s[8:11], s72 offen offset:1024 lds
    buffer_load_dwordx4 v78, s[8:11], s72 offen offset:2048 lds
    buffer_load_dwordx4 v79, s[8:11], s72 offen offset:3072 lds
    s_add_u32 s72, s60, 6
    s_and_b32 s72, s72, 7
    s_lshl_b32 s72, s72, 16
    s_mov_b32 m0, 115712
    s_nop 0
    buffer_load_dwordx4 v80, s[8:11], s72 offen offset:0 lds
    buffer_load_dwordx4 v81, s[8:11], s72 offen offset:1024 lds
    buffer_load_dwordx4 v82, s[8:11], s72 offen offset:2048 lds
    buffer_load_dwordx4 v83, s[8:11], s72 offen offset:3072 lds
    s_mov_b32 m0, 119808
    s_nop 0
    buffer_load_dwordx4 v84, s[8:11], s72 offen offset:0 lds
    buffer_load_dwordx4 v85, s[8:11], s72 offen offset:1024 lds
    buffer_load_dwordx4 v86, s[8:11], s72 offen offset:2048 lds
    buffer_load_dwordx4 v87, s[8:11], s72 offen offset:3072 lds
    s_add_u32 s72, s60, 7
    s_and_b32 s72, s72, 7
    s_lshl_b32 s72, s72, 16
    s_mov_b32 m0, 123904
    s_nop 0
    buffer_load_dwordx4 v80, s[8:11], s72 offen offset:0 lds
    buffer_load_dwordx4 v81, s[8:11], s72 offen offset:1024 lds
    buffer_load_dwordx4 v82, s[8:11], s72 offen offset:2048 lds
    buffer_load_dwordx4 v83, s[8:11], s72 offen offset:3072 lds
    s_mov_b32 m0, 128000
    s_nop 0
    buffer_load_dwordx4 v84, s[8:11], s72 offen offset:0 lds
    buffer_load_dwordx4 v85, s[8:11], s72 offen offset:1024 lds
    buffer_load_dwordx4 v86, s[8:11], s72 offen offset:2048 lds
    buffer_load_dwordx4 v87, s[8:11], s72 offen offset:3072 lds
    s_add_u32 s75, s61, 0
    s_mov_b32 m0, 132096
    s_nop 0
    buffer_load_dwordx4 v64, s[36:39], s75 offen offset:0 lds
    buffer_load_dwordx4 v65, s[36:39], s75 offen offset:1024 lds
    buffer_load_dwordx4 v66, s[36:39], s75 offen offset:2048 lds
    buffer_load_dwordx4 v67, s[36:39], s75 offen offset:3072 lds
    s_mov_b32 m0, 136192
    s_nop 0
    buffer_load_dwordx4 v68, s[36:39], s75 offen offset:0 lds
    buffer_load_dwordx4 v69, s[36:39], s75 offen offset:1024 lds
    buffer_load_dwordx4 v70, s[36:39], s75 offen offset:2048 lds
    s_add_u32 s75, s61, 57344
    s_mov_b32 m0, 139264
    s_nop 0
    buffer_load_dwordx4 v64, s[36:39], s75 offen offset:0 lds
    buffer_load_dwordx4 v65, s[36:39], s75 offen offset:1024 lds
    buffer_load_dwordx4 v66, s[36:39], s75 offen offset:2048 lds
    buffer_load_dwordx4 v67, s[36:39], s75 offen offset:3072 lds
    s_mov_b32 m0, 143360
    s_nop 0
    buffer_load_dwordx4 v68, s[36:39], s75 offen offset:0 lds
    buffer_load_dwordx4 v69, s[36:39], s75 offen offset:1024 lds
    buffer_load_dwordx4 v70, s[36:39], s75 offen offset:2048 lds
    s_mov_b32 s80, 0
KS_10:
    ds_read_b32 v23, v22
    s_add_u32 s80, s80, 1
    s_waitcnt lgkmcnt(0)
    v_readfirstlane_b32 s73, v23
    s_cmp_gt_u32 s80, 200000
    s_cbranch_scc1 KG_11
    s_cmp_eq_u32 s73, 1
    s_cbranch_scc1 KS_10
KG_11:
    s_add_u32 s75, s61, 114688
    s_mov_b32 m0, 146432
    s_nop 0
    buffer_load_dwordx4 v64, s[36:39], s75 offen offset:0 lds
    buffer_load_dwordx4 v65, s[36:39], s75 offen offset:1024 lds
    buffer_load_dwordx4 v66, s[36:39], s75 offen offset:2048 lds
    buffer_load_dwordx4 v67, s[36:39], s75 offen offset:3072 lds
    s_mov_b32 m0, 150528
    s_nop 0
    buffer_load_dwordx4 v68, s[36:39], s75 offen offset:0 lds
    buffer_load_dwordx4 v69, s[36:39], s75 offen offset:1024 lds
    buffer_load_dwordx4 v70, s[36:39], s75 offen offset:2048 lds
    s_add_u32 s75, s61, 172032
    s_mov_b32 m0, 153600
    s_nop 0
    buffer_load_dwordx4 v64, s[36:39], s75 offen offset:0 lds
    buffer_load_dwordx4 v65, s[36:39], s75 offen offset:1024 lds
    buffer_load_dwordx4 v66, s[36:39], s75 offen offset:2048 lds
    buffer_load_dwordx4 v67, s[36:39], s75 offen offset:3072 lds
    s_mov_b32 m0, 157696
    s_nop 0
    buffer_load_dwordx4 v68, s[36:39], s75 offen offset:0 lds
    buffer_load_dwordx4 v69, s[36:39], s75 offen offset:1024 lds
    buffer_load_dwordx4 v70, s[36:39], s75 offen offset:2048 lds
    s_waitcnt vmcnt(28)
    s_branch KV_6
KW_5:
    s_lshl_b32 s72, s26, 12
    s_add_u32 s72, s72, 65536
    s_mov_b32 s80, 0
    s_waitcnt vmcnt(0)
    ds_read_b64_tr_b16 v[164:165], v11 offset:0
    ds_read_b64_tr_b16 v[166:167], v11 offset:128
    ds_read_b64_tr_b16 v[168:169], v11 offset:1024
    ds_read_b64_tr_b16 v[170:171], v11 offset:1152
    ds_read_b64_tr_b16 v[172:173], v11 offset:2048
    ds_read_b64_tr_b16 v[174:175], v11 offset:2176
    ds_read_b64_tr_b16 v[176:177], v11 offset:3072
    ds_read_b64_tr_b16 v[178:179], v11 offset:3200
    ds_read_b64_tr_b16 v[180:181], v11 offset:4096
    ds_read_b64_tr_b16 v[182:183], v11 offset:4224
    ds_read_b64_tr_b16 v[184:185], v11 offset:5120
    ds_read_b64_tr_b16 v[186:187], v11 offset:5248
    ds_read_b64_tr_b16 v[188:189], v11 offset:6144
    ds_read_b64_tr_b16 v[190:191], v11 offset:6272
    ds_read_b64_tr_b16 v[192:193], v11 offset:7168
    ds_read_b64_tr_b16 v[194:195], v11 offset:7296
KS_8:
    ds_read_b32 v23, v22
    s_add_u32 s80, s80, 1
    s_waitcnt lgkmcnt(0)
    v_readfirstlane_b32 s73, v23
    s_cmp_gt_u32 s80, 200000
    s_cbranch_scc1 KG_9
    s_cmp_eq_u32 s73, 0
    s_cbranch_scc1 KS_8
KG_9:
    ds_read_b128 v[64:67], v10 offset:0
    ds_read_b128 v[68:71], v10 offset:64
    ds_read_b128 v[72:75], v10 offset:128
    ds_read_b128 v[76:79], v10 offset:192
    ds_read_b128 v[80:83], v10 offset:256
    ds_read_b128 v[84:87], v10 offset:320
    ds_read_b128 v[88:91], v10 offset:384
    s_bitcmp0_b32 s27, 2
    s_cbranch_scc0 KV_7
    s_waitcnt lgkmcnt(6)
    v_mfma_f32_16x16x32_bf16 v[228:231], v[164:167], v[64:67], 0
    ds_read_b128 v[92:95], v10 offset:448
    s_waitcnt lgkmcnt(6)
    v_mfma_f32_16x16x32_bf16 v[228:231], v[168:171], v[68:71], v[228:231]
    ds_read_b64_tr_b16 v[196:197], v11 offset:8192
    ds_read_b64_tr_b16 v[198:199], v11 offset:8320
    ds_read_b128 v[64:67], v10 offset:512
    s_waitcnt lgkmcnt(8)
    v_mfma_f32_16x16x32_bf16 v[228:231], v[172:175], v[72:75], v[228:231]
    ds_read_b64_tr_b16 v[200:201], v11 offset:9216
    ds_read_b64_tr_b16 v[202:203], v11 offset:9344
    ds_read_b128 v[68:71], v10 offset:576
    s_waitcnt lgkmcnt(10)
    v_mfma_f32_16x16x32_bf16 v[228:231], v[176:179], v[76:79], v[228:231]
    ds_read_b64_tr_b16 v[204:205], v11 offset:10240
    ds_read_b64_tr_b16 v[206:207], v11 offset:10368
    ds_read_b128 v[72:75], v10 offset:640
    s_waitcnt lgkmcnt(12)
    v_mfma_f32_16x16x32_bf16 v[228:231], v[180:183], v[80:83], v[228:231]
    ds_read_b64_tr_b16 v[208:209], v11 offset:11264
    ds_read_b64_tr_b16 v[210:211], v11 offset:11392
    ds_read_b128 v[76:79], v10 offset:704
    s_waitcnt lgkmcnt(14)
    v_mfma_f32_16x16x32_bf16 v[228:231], v[184:187], v[84:87], v[228:231]
    ds_read_b64_tr_b16 v[212:213], v11 offset:12288
    ds_read_b64_tr_b16 v[214:215], v11 offset:12416
    ds_read_b128 v[80:83], v10 offset:768
    s_waitcnt lgkmcnt(15)
    v_mfma_f32_16x16x32_bf16 v[228:231], v[188:191], v[88:91], v[228:231]
    ds_read_b64_tr_b16 v[216:217], v11 offset:13312
    ds_read_b64_tr_b16 v[218:219], v11 offset:13440
    ds_read_b128 v[84:87], v10 offset:832
    s_waitcnt lgkmcnt(15)
    v_mfma_f32_16x16x32_bf16 v[228:231], v[192:195], v[92:95], v[228:231]
    ds_read_b64_tr_b16 v[220:221], v11 offset:14336
    ds_read_b64_tr_b16 v[222:223], v11 offset:14464
    ds_read_b128 v[88:91], v10 offset:896
    s_waitcnt lgkmcnt(15)
    v_mfma_f32_16x16x32_bf16 v[228:231], v[196:199], v[64:67], v[228:231]
    ds_read_b64_tr_b16 v[224:225], v11 offset:15360
    ds_read_b64_tr_b16 v[226:227], v11 offset:15488
    ds_read_b128 v[92:95], v10 offset:960
    s_waitcnt lgkmcnt(15)
    v_mfma_f32_16x16x32_bf16 v[228:231], v[200:203], v[68:71], v[228:231]
    ds_read_b32 v24, v96
    s_waitcnt lgkmcnt(15)
    v_mfma_f32_16x16x32_bf16 v[228:231], v[204:207], v[72:75], v[228:231]
    s_waitcnt lgkmcnt(13)
    v_mfma_f32_16x16x32_bf16 v[228:231], v[208:211], v[76:79], v[228:231]
    s_waitcnt lgkmcnt(10)
    v_mfma_f32_16x16x32_bf16 v[228:231], v[212:215], v[80:83], v[228:231]
    s_waitcnt lgkmcnt(7)
    v_mfma_f32_16x16x32_bf16 v[228:231], v[216:219], v[84:87], v[228:231]
    s_waitcnt lgkmcnt(4)
    v_mfma_f32_16x16x32_bf16 v[228:231], v[220:223], v[88:91], v[228:231]
    s_waitcnt lgkmcnt(1)
    v_mfma_f32_16x16x32_bf16 v[228:231], v[224:227], v[92:95], v[228:231]
    v_mov_b32 v23, 2
    s_waitcnt lgkmcnt(0)
    ds_write_b32 v22, v23
    s_nop 4
    v_mul_f32 v228, v228, v24
    v_mul_f32 v229, v229, v24
    v_mul_f32 v230, v230, v24
    v_mul_f32 v231, v231, v24
    v_cvt_pk_bf16_f32 v228, v228, v229
    v_cvt_pk_bf16_f32 v229, v230, v231
    buffer_store_dwordx2 v[228:229], v99, s[44:47], s72 offen sc1
    s_branch KV_6
KV_7:
    s_waitcnt lgkmcnt(6)
    v_mfma_f32_16x16x32_bf16 v[228:231], v[64:67], v[164:167], 0
    ds_read_b128 v[92:95], v10 offset:448
    s_waitcnt lgkmcnt(6)
    v_mfma_f32_16x16x32_bf16 v[228:231], v[68:71], v[168:171], v[228:231]
    ds_read_b64_tr_b16 v[196:197], v11 offset:8192
    ds_read_b64_tr_b16 v[198:199], v11 offset:8320
    ds_read_b128 v[64:67], v10 offset:512
    s_waitcnt lgkmcnt(8)
    v_mfma_f32_16x16x32_bf16 v[228:231], v[72:75], v[172:175], v[228:231]
    ds_read_b64_tr_b16 v[200:201], v11 offset:9216
    ds_read_b64_tr_b16 v[202:203], v11 offset:9344
    ds_read_b128 v[68:71], v10 offset:576
    s_waitcnt lgkmcnt(10)
    v_mfma_f32_16x16x32_bf16 v[228:231], v[76:79], v[176:179], v[228:231]
    ds_read_b64_tr_b16 v[204:205], v11 offset:10240
    ds_read_b64_tr_b16 v[206:207], v11 offset:10368
    ds_read_b128 v[72:75], v10 offset:640
    s_waitcnt lgkmcnt(12)
    v_mfma_f32_16x16x32_bf16 v[228:231], v[80:83], v[180:183], v[228:231]
    ds_read_b64_tr_b16 v[208:209], v11 offset:11264
    ds_read_b64_tr_b16 v[210:211], v11 offset:11392
    ds_read_b128 v[76:79], v10 offset:704
    s_waitcnt lgkmcnt(14)
    v_mfma_f32_16x16x32_bf16 v[228:231], v[84:87], v[184:187], v[228:231]
    ds_read_b64_tr_b16 v[212:213], v11 offset:12288
    ds_read_b64_tr_b16 v[214:215], v11 offset:12416
    ds_read_b128 v[80:83], v10 offset:768
    s_waitcnt lgkmcnt(15)
    v_mfma_f32_16x16x32_bf16 v[228:231], v[88:91], v[188:191], v[228:231]
    ds_read_b64_tr_b16 v[216:217], v11 offset:13312
    ds_read_b64_tr_b16 v[218:219], v11 offset:13440
    ds_read_b128 v[84:87], v10 offset:832
    s_waitcnt lgkmcnt(15)
    v_mfma_f32_16x16x32_bf16 v[228:231], v[92:95], v[192:195], v[228:231]
    ds_read_b64_tr_b16 v[220:221], v11 offset:14336
    ds_read_b64_tr_b16 v[222:223], v11 offset:14464
    ds_read_b128 v[88:91], v10 offset:896
    s_waitcnt lgkmcnt(15)
    v_mfma_f32_16x16x32_bf16 v[228:231], v[64:67], v[196:199], v[228:231]
    ds_read_b64_tr_b16 v[224:225], v11 offset:15360
    ds_read_b64_tr_b16 v[226:227], v11 offset:15488
    ds_read_b128 v[92:95], v10 offset:960
    s_waitcnt lgkmcnt(15)
    v_mfma_f32_16x16x32_bf16 v[228:231], v[68:71], v[200:203], v[228:231]
    ds_read_b128 v[24:27], v97
    s_waitcnt lgkmcnt(15)
    v_mfma_f32_16x16x32_bf16 v[228:231], v[72:75], v[204:207], v[228:231]
    s_waitcnt lgkmcnt(13)
    v_mfma_f32_16x16x32_bf16 v[228:231], v[76:79], v[208:211], v[228:231]
    s_waitcnt lgkmcnt(10)
    v_mfma_f32_16x16x32_bf16 v[228:231], v[80:83], v[212:215], v[228:231]
    s_waitcnt lgkmcnt(7)
    v_mfma_f32_16x16x32_bf16 v[228:231], v[84:87], v[216:219], v[228:231]
    s_waitcnt lgkmcnt(4)
    v_mfma_f32_16x16x32_bf16 v[228:231], v[88:91], v[220:223], v[228:231]
    s_waitcnt lgkmcnt(1)
    v_mfma_f32_16x16x32_bf16 v[228:231], v[92:95], v[224:227], v[228:231]
    v_mov_b32 v23, 2
    s_waitcnt lgkmcnt(0)
    ds_write_b32 v22, v23
    s_nop 4
    v_mul_f32 v228, v228, v24
    v_mul_f32 v229, v229, v25
    v_mul_f32 v230, v230, v26
    v_mul_f32 v231, v231, v27
    v_cvt_pk_bf16_f32 v228, v228, v229
    v_cvt_pk_bf16_f32 v229, v230, v231
    buffer_store_dwordx2 v[228:229], v98, s[44:47], s72 offen offset:256 sc1
KV_6:
    s_branch LJ_4
LB_3:
    v_mov_b32 v12, 0
    v_mov_b32 v13, 0
    s_waitcnt vmcnt(5)
    v_dot2_f32_bf16 v12, v32, s66, v12
    v_dot2_f32_bf16 v13, v33, s66, v13
    v_dot2_f32_bf16 v12, v34, s66, v12
    v_dot2_f32_bf16 v13, v35, s66, v13
    v_dot2_f32_bf16 v12, v36, s66, v12
    v_dot2_f32_bf16 v13, v37, s66, v13
    v_dot2_f32_bf16 v12, v38, s66, v12
    v_dot2_f32_bf16 v13, v39, s66, v13
    v_dot2_f32_bf16 v12, v40, s66, v12
    v_dot2_f32_bf16 v13, v41, s66, v13
    v_dot2_f32_bf16 v12, v42, s66, v12
    v_dot2_f32_bf16 v13, v43, s66, v13
    v_dot2_f32_bf16 v12, v44, s66, v12
    v_dot2_f32_bf16 v13, v45, s66, v13
    v_dot2_f32_bf16 v12, v46, s66, v12
    v_dot2_f32_bf16 v13, v47, s66, v13
    s_waitcnt vmcnt(1)
    v_dot2_f32_bf16 v12, v48, s66, v12
    v_dot2_f32_bf16 v13, v49, s66, v13
    v_dot2_f32_bf16 v12, v50, s66, v12
    v_dot2_f32_bf16 v13, v51, s66, v13
    v_dot2_f32_bf16 v12, v52, s66, v12
    v_dot2_f32_bf16 v13, v53, s66, v13
    v_dot2_f32_bf16 v12, v54, s66, v12
    v_dot2_f32_bf16 v13, v55, s66, v13
    v_dot2_f32_bf16 v12, v56, s66, v12
    v_dot2_f32_bf16 v13, v57, s66, v13
    v_dot2_f32_bf16 v12, v58, s66, v12
    v_dot2_f32_bf16 v13, v59, s66, v13
    v_dot2_f32_bf16 v12, v60, s66, v12
    v_dot2_f32_bf16 v13, v61, s66, v13
    v_dot2_f32_bf16 v12, v62, s66, v12
    v_dot2_f32_bf16 v13, v63, s66, v13
    v_mov_b32 v24, 0
    v_mov_b32 v25, 0
    v_mov_b32 v26, 0
    v_mov_b32 v27, 0
    v_add_f32 v12, v12, v13
    s_nop 1
    v_add_f32_dpp v12, v12, v12 quad_perm:[1,0,3,2] row_mask:0xf bank_mask:0xf
    s_nop 1
    v_add_f32_dpp v12, v12, v12 quad_perm:[2,3,0,1] row_mask:0xf bank_mask:0xf
    s_nop 1
    v_add_f32_dpp v12, v12, v12 row_half_mirror row_mask:0xf bank_mask:0xf
    v_mul_f32 v12, 0x3b000000, v12
    v_cvt_pk_bf16_f32 v14, v12, v12
    v_and_b32 v14, 0xffff0000, v14
    v_sub_f32 v15, v12, v14
    v_xor_b32 v14, 0x80000000, v14
    v_dot2_f32_bf16 v16, v32, s67, v14
    v_dot2_f32_bf16 v17, v32, s68, v14
    v_dot2_f32_bf16 v18, v33, s67, v14
    v_dot2_f32_bf16 v19, v33, s68, v14
    v_dot2_f32_bf16 v20, v34, s67, v14
    v_dot2_f32_bf16 v21, v34, s68, v14
    v_dot2_f32_bf16 v22, v35, s67, v14
    v_dot2_f32_bf16 v23, v35, s68, v14
    v_pk_fma_f32 v[24:25], v[16:17], v[16:17], v[24:25]
    v_cvt_pk_bf16_f32 v32, v16, v17
    v_pk_fma_f32 v[26:27], v[18:19], v[18:19], v[26:27]
    v_cvt_pk_bf16_f32 v33, v18, v19
    v_pk_fma_f32 v[24:25], v[20:21], v[20:21], v[24:25]
    v_cvt_pk_bf16_f32 v34, v20, v21
    v_pk_fma_f32 v[26:27], v[22:23], v[22:23], v[26:27]
    v_cvt_pk_bf16_f32 v35, v22, v23
    ds_write_b128 v9, v[32:35] offset:0
    v_dot2_f32_bf16 v16, v36, s67, v14
    v_dot2_f32_bf16 v17, v36, s68, v14
    v_dot2_f32_bf16 v18, v37, s67, v14
    v_dot2_f32_bf16 v19, v37, s68, v14
    v_dot2_f32_bf16 v20, v38, s67, v14
    v_dot2_f32_bf16 v21, v38, s68, v14
    v_dot2_f32_bf16 v22, v39, s67, v14
    v_dot2_f32_bf16 v23, v39, s68, v14
    v_pk_fma_f32 v[24:25], v[16:17], v[16:17], v[24:25]
    v_cvt_pk_bf16_f32 v36, v16, v17
    v_pk_fma_f32 v[26:27], v[18:19], v[18:19], v[26:27]
    v_cvt_pk_bf16_f32 v37, v18, v19
    v_pk_fma_f32 v[24:25], v[20:21], v[20:21], v[24:25]
    v_cvt_pk_bf16_f32 v38, v20, v21
    v_pk_fma_f32 v[26:27], v[22:23], v[22:23], v[26:27]
    v_cvt_pk_bf16_f32 v39, v22, v23
    ds_write_b128 v9, v[36:39] offset:128
    v_dot2_f32_bf16 v16, v40, s67, v14
    v_dot2_f32_bf16 v17, v40, s68, v14
    v_dot2_f32_bf16 v18, v41, s67, v14
    v_dot2_f32_bf16 v19, v41, s68, v14
    v_dot2_f32_bf16 v20, v42, s67, v14
    v_dot2_f32_bf16 v21, v42, s68, v14
    v_dot2_f32_bf16 v22, v43, s67, v14
    v_dot2_f32_bf16 v23, v43, s68, v14
    v_pk_fma_f32 v[24:25], v[16:17], v[16:17], v[24:25]
    v_cvt_pk_bf16_f32 v40, v16, v17
    v_pk_fma_f32 v[26:27], v[18:19], v[18:19], v[26:27]
    v_cvt_pk_bf16_f32 v41, v18, v19
    v_pk_fma_f32 v[24:25], v[20:21], v[20:21], v[24:25]
    v_cvt_pk_bf16_f32 v42, v20, v21
    v_pk_fma_f32 v[26:27], v[22:23], v[22:23], v[26:27]
    v_cvt_pk_bf16_f32 v43, v22, v23
    ds_write_b128 v9, v[40:43] offset:256
    v_dot2_f32_bf16 v16, v44, s67, v14
    v_dot2_f32_bf16 v17, v44, s68, v14
    v_dot2_f32_bf16 v18, v45, s67, v14
    v_dot2_f32_bf16 v19, v45, s68, v14
    v_dot2_f32_bf16 v20, v46, s67, v14
    v_dot2_f32_bf16 v21, v46, s68, v14
    v_dot2_f32_bf16 v22, v47, s67, v14
    v_dot2_f32_bf16 v23, v47, s68, v14
    v_pk_fma_f32 v[24:25], v[16:17], v[16:17], v[24:25]
    v_cvt_pk_bf16_f32 v44, v16, v17
    v_pk_fma_f32 v[26:27], v[18:19], v[18:19], v[26:27]
    v_cvt_pk_bf16_f32 v45, v18, v19
    v_pk_fma_f32 v[24:25], v[20:21], v[20:21], v[24:25]
    v_cvt_pk_bf16_f32 v46, v20, v21
    v_pk_fma_f32 v[26:27], v[22:23], v[22:23], v[26:27]
    v_cvt_pk_bf16_f32 v47, v22, v23
    ds_write_b128 v9, v[44:47] offset:384
    v_dot2_f32_bf16 v16, v48, s67, v14
    v_dot2_f32_bf16 v17, v48, s68, v14
    v_dot2_f32_bf16 v18, v49, s67, v14
    v_dot2_f32_bf16 v19, v49, s68, v14
    v_dot2_f32_bf16 v20, v50, s67, v14
    v_dot2_f32_bf16 v21, v50, s68, v14
    v_dot2_f32_bf16 v22, v51, s67, v14
    v_dot2_f32_bf16 v23, v51, s68, v14
    v_pk_fma_f32 v[24:25], v[16:17], v[16:17], v[24:25]
    v_cvt_pk_bf16_f32 v48, v16, v17
    v_pk_fma_f32 v[26:27], v[18:19], v[18:19], v[26:27]
    v_cvt_pk_bf16_f32 v49, v18, v19
    v_pk_fma_f32 v[24:25], v[20:21], v[20:21], v[24:25]
    v_cvt_pk_bf16_f32 v50, v20, v21
    v_pk_fma_f32 v[26:27], v[22:23], v[22:23], v[26:27]
    v_cvt_pk_bf16_f32 v51, v22, v23
    ds_write_b128 v9, v[48:51] offset:512
    v_dot2_f32_bf16 v16, v52, s67, v14
    v_dot2_f32_bf16 v17, v52, s68, v14
    v_dot2_f32_bf16 v18, v53, s67, v14
    v_dot2_f32_bf16 v19, v53, s68, v14
    v_dot2_f32_bf16 v20, v54, s67, v14
    v_dot2_f32_bf16 v21, v54, s68, v14
    v_dot2_f32_bf16 v22, v55, s67, v14
    v_dot2_f32_bf16 v23, v55, s68, v14
    v_pk_fma_f32 v[24:25], v[16:17], v[16:17], v[24:25]
    v_cvt_pk_bf16_f32 v52, v16, v17
    v_pk_fma_f32 v[26:27], v[18:19], v[18:19], v[26:27]
    v_cvt_pk_bf16_f32 v53, v18, v19
    v_pk_fma_f32 v[24:25], v[20:21], v[20:21], v[24:25]
    v_cvt_pk_bf16_f32 v54, v20, v21
    v_pk_fma_f32 v[26:27], v[22:23], v[22:23], v[26:27]
    v_cvt_pk_bf16_f32 v55, v22, v23
    ds_write_b128 v9, v[52:55] offset:640
    v_dot2_f32_bf16 v16, v56, s67, v14
    v_dot2_f32_bf16 v17, v56, s68, v14
    v_dot2_f32_bf16 v18, v57, s67, v14
    v_dot2_f32_bf16 v19, v57, s68, v14
    v_dot2_f32_bf16 v20, v58, s67, v14
    v_dot2_f32_bf16 v21, v58, s68, v14
    v_dot2_f32_bf16 v22, v59, s67, v14
    v_dot2_f32_bf16 v23, v59, s68, v14
    v_pk_fma_f32 v[24:25], v[16:17], v[16:17], v[24:25]
    v_cvt_pk_bf16_f32 v56, v16, v17
    v_pk_fma_f32 v[26:27], v[18:19], v[18:19], v[26:27]
    v_cvt_pk_bf16_f32 v57, v18, v19
    v_pk_fma_f32 v[24:25], v[20:21], v[20:21], v[24:25]
    v_cvt_pk_bf16_f32 v58, v20, v21
    v_pk_fma_f32 v[26:27], v[22:23], v[22:23], v[26:27]
    v_cvt_pk_bf16_f32 v59, v22, v23
    ds_write_b128 v9, v[56:59] offset:768
    v_dot2_f32_bf16 v16, v60, s67, v14
    v_dot2_f32_bf16 v17, v60, s68, v14
    v_dot2_f32_bf16 v18, v61, s67, v14
    v_dot2_f32_bf16 v19, v61, s68, v14
    v_dot2_f32_bf16 v20, v62, s67, v14
    v_dot2_f32_bf16 v21, v62, s68, v14
    v_dot2_f32_bf16 v22, v63, s67, v14
    v_dot2_f32_bf16 v23, v63, s68, v14
    v_pk_fma_f32 v[24:25], v[16:17], v[16:17], v[24:25]
    v_cvt_pk_bf16_f32 v60, v16, v17
    v_pk_fma_f32 v[26:27], v[18:19], v[18:19], v[26:27]
    v_cvt_pk_bf16_f32 v61, v18, v19
    v_pk_fma_f32 v[24:25], v[20:21], v[20:21], v[24:25]
    v_cvt_pk_bf16_f32 v62, v20, v21
    v_pk_fma_f32 v[26:27], v[22:23], v[22:23], v[26:27]
    v_cvt_pk_bf16_f32 v63, v22, v23
    ds_write_b128 v9, v[60:63] offset:896
    v_pk_add_f32 v[24:25], v[24:25], v[26:27]
    v_add_f32 v12, v24, v25
    s_nop 1
    v_add_f32_dpp v12, v12, v12 quad_perm:[1,0,3,2] row_mask:0xf bank_mask:0xf
    s_nop 1
    v_add_f32_dpp v12, v12, v12 quad_perm:[2,3,0,1] row_mask:0xf bank_mask:0xf
    s_nop 1
    v_add_f32_dpp v12, v12, v12 row_half_mirror row_mask:0xf bank_mask:0xf
    v_mul_f32 v12, 0x3b000000, v12
    v_fma_f32 v12, -v15, v15, v12
    v_max_f32 v12, 0, v12
    v_cvt_pk_bf16_f32 v12, v12, v12
    v_and_b32 v12, 0xffff0000, v12
    v_add_f32 v12, 0x3727c5ac, v12
    v_cvt_pk_bf16_f32 v12, v12, v12
    v_and_b32 v12, 0xffff0000, v12
    v_sqrt_f32 v12, v12
    v_lshlrev_b32 v16, 2, v131
    v_cvt_pk_bf16_f32 v12, v12, v12
    v_and_b32 v12, 0xffff0000, v12
    v_rcp_f32 v13, v12
    v_add_u32 v16, 162816, v16
    ds_write_b32 v16, v13
LJ_4:
    s_lshl_b32 s72, s30, 7
    s_add_u32 s72, s72, 162816
    v_and_b32 v16, 31, v1
    v_lshl_add_u32 v16, v16, 2, s72
    v_and_b32 v18, 15, v1
    v_lshl_add_u32 v17, v18, 2, s72
    s_mov_b32 s56, s20
    s_mov_b32 s57, s21
    s_mov_b32 s58, 0x200000
    s_add_u32 s72, s61, 229376
    s_sub_u32 s61, s72, s38
    s_cselect_b32 s61, s72, s61
    s_waitcnt lgkmcnt(0)
    s_mul_i32 s29, s29, 0x9e3779b1
    s_add_u32 s29, s29, 0x7f4a7c15
    s_barrier
    ds_read_b32 v12, v16
    ds_read_b32 v13, v16
    ds_read_b32 v14, v17
    ds_read_b32 v15, v17 offset:64
    ds_read_b64_tr_b16 v[64:65], v240 offset:0
    ds_read_b64_tr_b16 v[66:67], v240 offset:512
    ds_read_b128 v[80:83], v241 offset:0
    ds_read_b128 v[84:87], v241 offset:16640
    ds_read_b64_tr_b16 v[68:69], v240 offset:1024
    ds_read_b64_tr_b16 v[70:71], v240 offset:1536
    ds_read_b128 v[88:91], v241 offset:16
    ds_read_b128 v[92:95], v241 offset:16656
    ds_read_b64_tr_b16 v[72:73], v240 offset:2048
    ds_read_b64_tr_b16 v[74:75], v240 offset:2560
    ds_read_b128 v[96:99], v241 offset:32
    ds_read_b128 v[100:103], v241 offset:16672
    s_waitcnt lgkmcnt(8)
    v_mfma_f32_16x16x32_bf16 v[232:235], v[64:67], v[80:83], 0
    ds_read_b64_tr_b16 v[76:77], v240 offset:3072
    ds_read_b64_tr_b16 v[78:79], v240 offset:3584
    v_mfma_f32_16x16x32_bf16 v[236:239], v[64:67], v[84:87], 0
    ds_read_b128 v[104:107], v241 offset:48
    ds_read_b128 v[108:111], v241 offset:16688
    v_mov_b32 v48, 0
    v_mov_b32 v49, 0
    v_mov_b32 v50, 0
    v_mov_b32 v51, 0
    s_waitcnt lgkmcnt(8)
    v_mfma_f32_16x16x32_bf16 v[232:235], v[68:71], v[88:91], v[232:235]
    ds_read_b64_tr_b16 v[64:65], v240 offset:4096
    ds_read_b64_tr_b16 v[66:67], v240 offset:4608
    v_mfma_f32_16x16x32_bf16 v[236:239], v[68:71], v[92:95], v[236:239]
    ds_read_b128 v[80:83], v241 offset:64
    ds_read_b128 v[84:87], v241 offset:16704
    v_mov_b32 v52, 0
    v_mov_b32 v53, 0
    v_mov_b32 v54, 0
    v_mov_b32 v55, 0
    s_waitcnt lgkmcnt(8)
    v_mfma_f32_16x16x32_bf16 v[232:235], v[72:75], v[96:99], v[232:235]
    ds_read_b64_tr_b16 v[68:69], v240 offset:5120
    ds_read_b64_tr_b16 v[70:71], v240 offset:5632
    v_mfma_f32_16x16x32_bf16 v[236:239], v[72:75], v[100:103], v[236:239]
    ds_read_b128 v[88:91], v241 offset:80
    ds_read_b128 v[92:95], v241 offset:16720
    v_mov_b32 v56, 0
    v_mov_b32 v57, 0
    v_mov_b32 v58, 0
    v_mov_b32 v59, 0
    s_waitcnt lgkmcnt(8)
    v_mfma_f32_16x16x32_bf16 v[232:235], v[76:79], v[104:107], v[232:235]
    ds_read_b64_tr_b16 v[72:73], v240 offset:6144
    ds_read_b64_tr_b16 v[74:75], v240 offset:6656
    v_mfma_f32_16x16x32_bf16 v[236:239], v[76:79], v[108:111], v[236:239]
    ds_read_b128 v[96:99], v241 offset:96
    ds_read_b128 v[100:103], v241 offset:16736
    v_mov_b32 v60, 0
    v_mov_b32 v61, 0
    v_mov_b32 v62, 0
    v_mov_b32 v63, 0
    s_waitcnt lgkmcnt(8)
    v_mfma_f32_16x16x32_bf16 v[232:235], v[64:67], v[80:83], v[232:235]
    ds_read_b64_tr_b16 v[76:77], v240 offset:7168
    ds_read_b64_tr_b16 v[78:79], v240 offset:7680
    v_mfma_f32_16x16x32_bf16 v[236:239], v[64:67], v[84:87], v[236:239]
    ds_read_b128 v[104:107], v241 offset:112
    ds_read_b128 v[108:111], v241 offset:16752
    v_and_b32 v30, 27, v1
    v_cmp_eq_u32 vcc, 16, v30
    v_mov_b32 v30, s66
    s_nop 0
    v_cndmask_b32 v30, 0, v30, vcc
    s_waitcnt lgkmcnt(8)
    v_mfma_f32_16x16x32_bf16 v[232:235], v[68:71], v[88:91], v[232:235]
    ds_read_b64_tr_b16 v[64:65], v240 offset:8192
    ds_read_b64_tr_b16 v[66:67], v240 offset:8704
    v_mfma_f32_16x16x32_bf16 v[236:239], v[68:71], v[92:95], v[236:239]
    ds_read_b128 v[80:83], v241 offset:128
    ds_read_b128 v[84:87], v241 offset:16768
    v_mov_b32 v36, v30
    v_mov_b32 v37, v30
    v_mov_b32 v38, v30
    v_mov_b32 v39, v30
    s_cmp_lg_u32 s28, 0
    s_cbranch_scc1 KF_12
    s_waitcnt vmcnt(0)
    s_lshl3_add_u32 s72, s26, s27
    s_lshl_b32 s72, s72, 4
    s_add_u32 s72, s72, 4096
    v_mov_b32 v31, s29
    s_mov_b64 exec, 1
    buffer_store_dword v31, off, s[44:47], s72 sc1
    s_mov_b64 exec, -1
KF_12:
    s_waitcnt lgkmcnt(8)
    v_mfma_f32_16x16x32_bf16 v[232:235], v[72:75], v[96:99], v[232:235]
    ds_read_b64_tr_b16 v[68:69], v240 offset:9216
    ds_read_b64_tr_b16 v[70:71], v240 offset:9728
    v_mfma_f32_16x16x32_bf16 v[236:239], v[72:75], v[100:103], v[236:239]
    ds_read_b128 v[88:91], v241 offset:144
    ds_read_b128 v[92:95], v241 offset:16784
    v_mov_b32 v40, v30
    v_mov_b32 v41, v30
    v_mov_b32 v42, v30
    v_mov_b32 v43, v30
    s_waitcnt lgkmcnt(8)
    v_mfma_f32_16x16x32_bf16 v[232:235], v[76:79], v[104:107], v[232:235]
    ds_read_b64_tr_b16 v[72:73], v240 offset:10240
    ds_read_b64_tr_b16 v[74:75], v240 offset:10752
    v_mfma_f32_16x16x32_bf16 v[236:239], v[76:79], v[108:111], v[236:239]
    ds_read_b128 v[96:99], v241 offset:160
    ds_read_b128 v[100:103], v241 offset:16800
    v_mov_b32 v44, v30
    v_mov_b32 v45, v30
    v_mov_b32 v46, v30
    v_mov_b32 v47, v30
    s_waitcnt lgkmcnt(8)
    v_mfma_f32_16x16x32_bf16 v[232:235], v[64:67], v[80:83], v[232:235]
    ds_read_b64_tr_b16 v[76:77], v240 offset:11264
    ds_read_b64_tr_b16 v[78:79], v240 offset:11776
    v_mfma_f32_16x16x32_bf16 v[236:239], v[64:67], v[84:87], v[236:239]
    ds_read_b128 v[104:107], v241 offset:176
    ds_read_b128 v[108:111], v241 offset:16816
    s_waitcnt lgkmcnt(8)
    v_mfma_f32_16x16x32_bf16 v[232:235], v[68:71], v[88:91], v[232:235]
    ds_read_b64_tr_b16 v[64:65], v240 offset:12288
    ds_read_b64_tr_b16 v[66:67], v240 offset:12800
    v_mfma_f32_16x16x32_bf16 v[236:239], v[68:71], v[92:95], v[236:239]
    ds_read_b128 v[80:83], v241 offset:192
    ds_read_b128 v[84:87], v241 offset:16832
    v_mov_b32 v24, -1
    v_mov_b32 v25, -1
    v_mov_b32 v26, -1
    v_mov_b32 v27, -1
    buffer_store_dwordx4 v[24:27], v3, s[44:47], s22 offen sc1
    s_waitcnt lgkmcnt(8)
    v_mfma_f32_16x16x32_bf16 v[232:235], v[72:75], v[96:99], v[232:235]
    ds_read_b64_tr_b16 v[68:69], v240 offset:13312
    ds_read_b64_tr_b16 v[70:71], v240 offset:13824
    v_mfma_f32_16x16x32_bf16 v[236:239], v[72:75], v[100:103], v[236:239]
    ds_read_b128 v[88:91], v241 offset:208
    ds_read_b128 v[92:95], v241 offset:16848
    s_waitcnt lgkmcnt(8)
    v_mfma_f32_16x16x32_bf16 v[232:235], v[76:79], v[104:107], v[232:235]
    ds_read_b64_tr_b16 v[72:73], v240 offset:14336
    ds_read_b64_tr_b16 v[74:75], v240 offset:14848
    v_mfma_f32_16x16x32_bf16 v[236:239], v[76:79], v[108:111], v[236:239]
    ds_read_b128 v[96:99], v241 offset:224
    ds_read_b128 v[100:103], v241 offset:16864
    s_waitcnt lgkmcnt(8)
    v_mfma_f32_16x16x32_bf16 v[232:235], v[64:67], v[80:83], v[232:235]
    ds_read_b64_tr_b16 v[76:77], v240 offset:15360
    ds_read_b64_tr_b16 v[78:79], v240 offset:15872
    v_mfma_f32_16x16x32_bf16 v[236:239], v[64:67], v[84:87], v[236:239]
    ds_read_b128 v[104:107], v241 offset:240
    ds_read_b128 v[108:111], v241 offset:16880
    s_waitcnt lgkmcnt(8)
    v_mfma_f32_16x16x32_bf16 v[232:235], v[68:71], v[88:91], v[232:235]
    v_mfma_f32_16x16x32_bf16 v[236:239], v[68:71], v[92:95], v[236:239]
    s_waitcnt lgkmcnt(4)
    v_mfma_f32_16x16x32_bf16 v[232:235], v[72:75], v[96:99], v[232:235]
    v_mfma_f32_16x16x32_bf16 v[236:239], v[72:75], v[100:103], v[236:239]
    s_waitcnt lgkmcnt(0)
    v_mfma_f32_16x16x32_bf16 v[232:235], v[76:79], v[104:107], v[232:235]
    v_mfma_f32_16x16x32_bf16 v[236:239], v[76:79], v[108:111], v[236:239]
    v_mul_f32 v14, 0x3eb8aa3b, v14
    v_mul_f32 v15, 0x3eb8aa3b, v15
    s_nop 5
    v_mul_f32 v232, v232, v14
    v_mul_f32 v233, v233, v14
    v_mul_f32 v234, v234, v14
    v_mul_f32 v235, v235, v14
    v_mul_f32 v236, v236, v15
    v_mul_f32 v237, v237, v15
    v_mul_f32 v238, v238, v15
    v_mul_f32 v239, v239, v15
    v_cvt_pk_bf16_f32 v16, v232, v233
    v_cvt_pk_bf16_f32 v17, v234, v235
    v_cvt_pk_bf16_f32 v18, v236, v237
    v_cvt_pk_bf16_f32 v19, v238, v239
    s_nop 1
    v_permlane16_swap_b32 v16, v18
    v_permlane16_swap_b32 v17, v19
    s_nop 0
    v_permlane32_swap_b32 v16, v18
    v_permlane32_swap_b32 v17, v19
    s_cmp_lg_u32 s28, 1
    s_cbranch_scc1 W0_13
    s_waitcnt vmcnt(15)
W0_13:
    s_barrier
    s_add_u32 m0, s62, 99328
    s_nop 0
    buffer_load_dwordx4 v7, s[36:39], s61 offen lds
    s_add_u32 m0, s63, 99328
    s_add_u32 s72, s61, 114688
    buffer_load_dwordx4 v8, s[36:39], s61 offen lds
    s_sub_u32 s61, s72, s38
    s_cselect_b32 s61, s72, s61
    s_add_u32 m0, s62, 113664
    s_nop 0
    buffer_load_dwordx4 v7, s[36:39], s61 offen lds
    s_add_u32 m0, s63, 113664
    s_add_u32 s72, s61, 114688
    buffer_load_dwordx4 v8, s[36:39], s61 offen lds
    s_sub_u32 s61, s72, s38
    s_cselect_b32 s61, s72, s61
    ds_read_b64_tr_b16 v[168:169], v5 offset:32768
    ds_read_b64_tr_b16 v[170:171], v5 offset:34560
    ds_read_b64_tr_b16 v[172:173], v6 offset:32768
    ds_read_b64_tr_b16 v[174:175], v6 offset:34560
    ds_read_b128 v[164:167], v4 offset:0
    ds_read_b64_tr_b16 v[180:181], v5 offset:39936
    ds_read_b64_tr_b16 v[182:183], v5 offset:41728
    ds_read_b64_tr_b16 v[184:185], v6 offset:39936
    ds_read_b64_tr_b16 v[186:187], v6 offset:41728
    ds_read_b128 v[176:179], v4 offset:32
    s_waitcnt vmcnt(5) lgkmcnt(0)
    s_barrier
    v_mfma_f32_32x32x16_bf16 v[132:147], v[168:171], v[164:167], 0
    ds_read_b64_tr_b16 v[192:193], v5 offset:47104
    ds_read_b64_tr_b16 v[194:195], v5 offset:48896
    ds_read_b64_tr_b16 v[196:197], v6 offset:47104
    v_mfma_f32_32x32x16_bf16 v[148:163], v[172:175], v[164:167], 0
    ds_read_b64_tr_b16 v[198:199], v6 offset:48896
    ds_read_b128 v[188:191], v4 offset:64
    ds_read_b64_tr_b16 v[204:205], v5 offset:54272
    s_add_u32 m0, s62, 132096
    s_nop 0
    buffer_load_dwordx4 v7, s[36:39], s61 offen lds
    v_mfma_f32_32x32x16_bf16 v[132:147], v[180:183], v[176:179], v[132:147]
    ds_read_b64_tr_b16 v[206:207], v5 offset:56064
    ds_read_b64_tr_b16 v[208:209], v6 offset:54272
    ds_read_b64_tr_b16 v[210:211], v6 offset:56064
    ds_read_b128 v[200:203], v4 offset:96
    v_mfma_f32_32x32x16_bf16 v[148:163], v[184:187], v[176:179], v[148:163]
    s_add_u32 m0, s63, 132096
    s_add_u32 s72, s61, 114688
    buffer_load_dwordx4 v8, s[36:39], s61 offen lds
    s_sub_u32 s61, s72, s38
    s_cselect_b32 s61, s72, s61
    s_waitcnt vmcnt(4) lgkmcnt(0)
    s_barrier
    s_cmp_lg_u32 s28, 7
    s_cbranch_scc1 KP_14
    s_mov_b32 s73, 4096
    buffer_load_dword v20, v3, s[44:47], s73 offen offset:0 sc1
    buffer_load_dword v21, v3, s[44:47], s73 offen offset:1024 sc1
    buffer_load_dword v22, v3, s[44:47], s73 offen offset:2048 sc1
    buffer_load_dword v23, v3, s[44:47], s73 offen offset:3072 sc1
KP_14:
    v_mfma_f32_32x32x16_bf16 v[132:147], v[192:195], v[188:191], v[132:147]
    ds_read_b64_tr_b16 v[168:169], v5 offset:0
    ds_read_b64_tr_b16 v[170:171], v5 offset:1792
    ds_read_b64_tr_b16 v[172:173], v6 offset:0
    v_mfma_f32_32x32x16_bf16 v[148:163], v[196:199], v[188:191], v[148:163]
    ds_read_b64_tr_b16 v[174:175], v6 offset:1792
    ds_read_b128 v[164:167], v4 offset:128
    ds_read_b64_tr_b16 v[180:181], v5 offset:7168
    s_add_u32 m0, s62, 146432
    s_nop 0
    buffer_load_dwordx4 v7, s[36:39], s61 offen lds
    v_mfma_f32_32x32x16_bf16 v[132:147], v[204:207], v[200:203], v[132:147]
    ds_read_b64_tr_b16 v[182:183], v5 offset:8960
    ds_read_b64_tr_b16 v[184:185], v6 offset:7168
    ds_read_b64_tr_b16 v[186:187], v6 offset:8960
    ds_read_b128 v[176:179], v4 offset:160
    v_mfma_f32_32x32x16_bf16 v[148:163], v[208:211], v[200:203], v[148:163]
    s_add_u32 m0, s63, 146432
    s_add_u32 s72, s61, 114688
    buffer_load_dwordx4 v8, s[36:39], s61 offen lds
    s_sub_u32 s61, s72, s38
    s_cselect_b32 s61, s72, s61
    s_waitcnt vmcnt(4) lgkmcnt(0)
    s_barrier
    v_mfma_f32_32x32x16_bf16 v[132:147], v[168:171], v[164:167], v[132:147]
    ds_read_b64_tr_b16 v[192:193], v5 offset:14336
    ds_read_b64_tr_b16 v[194:195], v5 offset:16128
    ds_read_b64_tr_b16 v[196:197], v6 offset:14336
    v_mfma_f32_32x32x16_bf16 v[148:163], v[172:175], v[164:167], v[148:163]
    ds_read_b64_tr_b16 v[198:199], v6 offset:16128
    ds_read_b128 v[188:191], v4 offset:192
    ds_read_b64_tr_b16 v[204:205], v5 offset:21504
    s_add_u32 m0, s62, 99328
    s_nop 0
    buffer_load_dwordx4 v7, s[36:39], s61 offen lds
    v_mfma_f32_32x32x16_bf16 v[132:147], v[180:183], v[176:179], v[132:147]
    ds_read_b64_tr_b16 v[206:207], v5 offset:23296
    ds_read_b64_tr_b16 v[208:209], v6 offset:21504
    ds_read_b64_tr_b16 v[210:211], v6 offset:23296
    ds_read_b128 v[200:203], v4 offset:224
    v_mfma_f32_32x32x16_bf16 v[148:163], v[184:187], v[176:179], v[148:163]
    s_add_u32 m0, s63, 99328
    s_add_u32 s72, s61, 114688
    buffer_load_dwordx4 v8, s[36:39], s61 offen lds
    s_sub_u32 s61, s72, s38
    s_cselect_b32 s61, s72, s61
    s_waitcnt vmcnt(4) lgkmcnt(0)
    s_cmp_lg_u32 s28, 7
    s_cbranch_scc1 KC_15
    s_waitcnt vmcnt(4)
    s_mov_b32 s80, 0
PL_17:
    v_xor_b32 v20, s29, v20
    v_xor_b32 v21, s29, v21
    v_xor_b32 v22, s29, v22
    v_xor_b32 v23, s29, v23
    v_or_b32 v20, v20, v21
    v_or_b32 v20, v20, v22
    v_or_b32 v20, v20, v23
    v_cmp_ne_u32 vcc, 0, v20
    s_nop 4
    s_cbranch_vccz PD_16
    s_add_u32 s80, s80, 1
    s_cmp_gt_u32 s80, 200000
    s_cbranch_scc1 PD_16
    s_sleep 8
    buffer_load_dword v20, v3, s[44:47], s73 offen offset:0 sc1
    buffer_load_dword v21, v3, s[44:47], s73 offen offset:1024 sc1
    buffer_load_dword v22, v3, s[44:47], s73 offen offset:2048 sc1
    buffer_load_dword v23, v3, s[44:47], s73 offen offset:3072 sc1
    s_waitcnt vmcnt(0)
    s_branch PL_17
PD_16:
KC_15:
    s_barrier
    v_mfma_f32_32x32x16_bf16 v[132:147], v[192:195], v[188:191], v[132:147]
    ds_read_b64_tr_b16 v[168:169], v5 offset:32768
    ds_read_b64_tr_b16 v[170:171], v5 offset:34560
    ds_read_b64_tr_b16 v[172:173], v6 offset:32768
    s_add_u32 m0, s83, 0
    s_add_u32 s72, s82, 0
    buffer_load_dwordx4 v3, s[44:47], s72 offen sc1 lds
    v_mfma_f32_32x32x16_bf16 v[148:163], v[196:199], v[188:191], v[148:163]
    ds_read_b64_tr_b16 v[174:175], v6 offset:34560
    ds_read_b128 v[164:167], v4 offset:256
    ds_read_b64_tr_b16 v[180:181], v5 offset:39936
    s_add_u32 m0, s83, 16384
    s_add_u32 s72, s82, 8192
    buffer_load_dwordx4 v3, s[44:47], s72 offen sc1 lds
    v_mfma_f32_32x32x16_bf16 v[132:147], v[204:207], v[200:203], v[132:147]
    ds_read_b64_tr_b16 v[182:183], v5 offset:41728
    ds_read_b64_tr_b16 v[184:185], v6 offset:39936
    ds_read_b64_tr_b16 v[186:187], v6 offset:41728
    ds_read_b128 v[176:179], v4 offset:288
    s_add_u32 m0, s62, 113664
    s_nop 0
    buffer_load_dwordx4 v7, s[36:39], s61 offen lds
    v_mfma_f32_32x32x16_bf16 v[148:163], v[208:211], v[200:203], v[148:163]
    s_add_u32 m0, s63, 113664
    s_add_u32 s72, s61, 114688
    buffer_load_dwordx4 v8, s[36:39], s61 offen lds
    s_sub_u32 s61, s72, s38
    s_cselect_b32 s61, s72, s61
    s_waitcnt vmcnt(6) lgkmcnt(0)
    s_barrier
    v_mfma_f32_32x32x16_bf16 v[132:147], v[168:171], v[164:167], v[132:147]
    ds_read_b64_tr_b16 v[192:193], v5 offset:47104
    ds_read_b64_tr_b16 v[194:195], v5 offset:48896
    ds_read_b64_tr_b16 v[196:197], v6 offset:47104
    v_mfma_f32_32x32x16_bf16 v[148:163], v[172:175], v[164:167], v[148:163]
    ds_read_b64_tr_b16 v[198:199], v6 offset:48896
    ds_read_b128 v[188:191], v4 offset:320
    ds_read_b64_tr_b16 v[204:205], v5 offset:54272
    s_add_u32 m0, s83, 8192
    s_add_u32 s72, s82, 16384
    buffer_load_dwordx4 v3, s[44:47], s72 offen sc1 lds
    v_mfma_f32_32x32x16_bf16 v[132:147], v[180:183], v[176:179], v[132:147]
    ds_read_b64_tr_b16 v[206:207], v5 offset:56064
    ds_read_b64_tr_b16 v[208:209], v6 offset:54272
    ds_read_b64_tr_b16 v[210:211], v6 offset:56064
    ds_read_b128 v[200:203], v4 offset:352
    s_add_u32 m0, s62, 132096
    s_nop 0
    buffer_load_dwordx4 v7, s[36:39], s61 offen lds
    v_mfma_f32_32x32x16_bf16 v[148:163], v[184:187], v[176:179], v[148:163]
    s_add_u32 m0, s63, 132096
    s_add_u32 s72, s61, 114688
    buffer_load_dwordx4 v8, s[36:39], s61 offen lds
    s_sub_u32 s61, s72, s38
    s_cselect_b32 s61, s72, s61
    s_waitcnt vmcnt(3) lgkmcnt(0)
    s_barrier
    ds_read_b128 v[20:23], v120 offset:0
    ds_read_b128 v[24:27], v120 offset:2048
    s_mov_b64 exec, s[70:71]
    ds_read_b128 v[36:39], v121 offset:0
    ds_read_b128 v[40:43], v121 offset:1024
    s_mov_b64 exec, -1
    v_mfma_f32_32x32x16_bf16 v[132:147], v[192:195], v[188:191], v[132:147]
    s_waitcnt lgkmcnt(2)
    v_mfma_f32_32x32x16_bf16 v[80:95], v[20:23], v[16:19], 0
    v_mfma_f32_32x32x16_bf16 v[96:111], v[24:27], v[16:19], 0
    v_mfma_f32_32x32x16_bf16 v[148:163], v[196:199], v[188:191], v[148:163]
    s_add_u32 m0, s62, 146432
    s_nop 0
    buffer_load_dwordx4 v7, s[36:39], s61 offen lds
    v_mfma_f32_32x32x16_bf16 v[132:147], v[204:207], v[200:203], v[132:147]
    s_nop 7
    s_nop 1
    v_max3_f32 v28, v80, v81, v82
    v_max_f32 v28, v28, v83
    v_max3_f32 v28, v28, v84, v85
    v_max3_f32 v28, v28, v86, v87
    v_max3_f32 v28, v28, v88, v89
    v_max3_f32 v28, v28, v90, v91
    v_max3_f32 v28, v28, v92, v93
    v_max3_f32 v28, v28, v94, v95
    v_max3_f32 v28, v28, v96, v97
    v_max3_f32 v28, v28, v98, v99
    v_max3_f32 v28, v28, v100, v101
    v_max3_f32 v28, v28, v102, v103
    v_max3_f32 v28, v28, v104, v105
    v_max3_f32 v28, v28, v106, v107
    v_max3_f32 v28, v28, v108, v109
    v_max3_f32 v28, v28, v110, v111
    v_mfma_f32_32x32x16_bf16 v[148:163], v[208:211], v[200:203], v[148:163]
    v_mov_b32 v31, v28
    s_nop 1
    v_permlane32_swap_b32 v31, v28
    s_nop 1
    v_max_f32 v28, v28, v31
    v_add_f32 v28, 0x42c80000, v28
    v_xor_b32 v64, 0x80000000, v28
    v_mov_b32 v65, v64
    v_mov_b32 v66, v64
    v_mov_b32 v67, v64
    v_mov_b32 v68, v64
    v_mov_b32 v69, v64
    v_mov_b32 v70, v64
    v_mov_b32 v71, v64
    v_mov_b32 v72, v64
    v_mov_b32 v73, v64
    v_mov_b32 v74, v64
    v_mov_b32 v75, v64
    v_mov_b32 v76, v64
    v_mov_b32 v77, v64
    v_mov_b32 v78, v64
    v_mov_b32 v79, v64
    s_add_u32 m0, s63, 146432
    s_add_u32 s72, s61, 114688
    buffer_load_dwordx4 v8, s[36:39], s61 offen lds
    s_sub_u32 s61, s72, s38
    s_cselect_b32 s61, s72, s61
    s_cmp_lt_u32 s31, 3
    s_cselect_b64 vcc, -1, 0
    s_nop 1
    v_mfma_f32_32x32x16_bf16 v[80:95], v[20:23], v[16:19], v[64:79]
    ds_read_b128 v[20:23], v120 offset:2048
    s_nop 7
    s_nop 2
    v_exp_f32 v80, v80
    v_exp_f32 v81, v81
    v_exp_f32 v82, v82
    s_setprio 3
    s_waitcnt lgkmcnt(0)
    v_exp_f32 v83, v83
    v_exp_f32 v84, v84
    v_exp_f32 v85, v85
    v_exp_f32 v86, v86
    v_mfma_f32_32x32x16_bf16 v[96:111], v[20:23], v[16:19], v[64:79]
    ds_read_b128 v[20:23], v120 offset:4096
    v_exp_f32 v87, v87
    v_exp_f32 v88, v88
    v_exp_f32 v89, v89
    v_exp_f32 v90, v90
    v_exp_f32 v91, v91
    v_smfmac_f32_32x32x32_bf16 v[48:63], v[36:39], v[80:87], v122
    s_mov_b64 exec, s[70:71]
    ds_read_b128 v[36:39], v121 offset:2048
    ds_read_b128 v[44:47], v121 offset:3072
    s_mov_b64 exec, -1
    s_add_u32 m0, s83, 24576
    s_add_u32 s72, s82, 24576
    buffer_load_dwordx4 v3, s[44:47], s72 offen sc1 lds
    v_exp_f32 v92, v92
    v_exp_f32 v93, v93
    ds_read_b64_tr_b16 v[112:113], v5 offset:0
    ds_read_b64_tr_b16 v[114:115], v5 offset:1792
    v_exp_f32 v94, v94
    s_cbranch_vccz SD_18
    ds_read_b64_tr_b16 v[116:117], v6 offset:0
    ds_read_b64_tr_b16 v[118:119], v6 offset:1792
SD_18:
    ds_read_b128 v[32:35], v4 offset:384
    v_exp_f32 v95, v95
    v_exp_f32 v96, v96
    v_exp_f32 v97, v97
    v_exp_f32 v98, v98
    v_smfmac_f32_32x32x32_bf16 v[48:63], v[40:43], v[88:95], v122
    s_setprio 2
    s_waitcnt lgkmcnt(0)
    v_exp_f32 v99, v99
    v_exp_f32 v100, v100
    v_exp_f32 v101, v101
    v_exp_f32 v102, v102
    v_mfma_f32_32x32x16_bf16 v[80:95], v[20:23], v[16:19], v[64:79]
    ds_read_b128 v[20:23], v120 offset:6144
    v_exp_f32 v103, v103
    v_exp_f32 v104, v104
    v_exp_f32 v105, v105
    v_exp_f32 v106, v106
    v_exp_f32 v107, v107
    v_smfmac_f32_32x32x32_bf16 v[48:63], v[36:39], v[96:103], v122
    s_mov_b64 exec, s[70:71]
    ds_read_b128 v[36:39], v121 offset:4096
    ds_read_b128 v[40:43], v121 offset:5120
    s_mov_b64 exec, -1
    v_exp_f32 v108, v108
    v_exp_f32 v109, v109
    v_mfma_f32_32x32x16_bf16 v[132:147], v[112:115], v[32:35], v[132:147]
    ds_read_b64_tr_b16 v[112:113], v5 offset:7168
    ds_read_b64_tr_b16 v[114:115], v5 offset:8960
    v_exp_f32 v110, v110
    s_cbranch_vccz SD_19
    v_mfma_f32_32x32x16_bf16 v[148:163], v[116:119], v[32:35], v[148:163]
    ds_read_b64_tr_b16 v[116:117], v6 offset:7168
    ds_read_b64_tr_b16 v[118:119], v6 offset:8960
SD_19:
    ds_read_b128 v[32:35], v4 offset:416
    v_exp_f32 v111, v111
    v_exp_f32 v80, v80
    v_exp_f32 v81, v81
    v_exp_f32 v82, v82
    v_smfmac_f32_32x32x32_bf16 v[48:63], v[44:47], v[104:111], v122
    s_setprio 1
    s_waitcnt lgkmcnt(0)
    v_exp_f32 v83, v83
    v_exp_f32 v84, v84
    v_exp_f32 v85, v85
    v_exp_f32 v86, v86
    v_mfma_f32_32x32x16_bf16 v[96:111], v[20:23], v[16:19], v[64:79]
    ds_read_b128 v[20:23], v120 offset:16384
    v_exp_f32 v87, v87
    v_exp_f32 v88, v88
    v_exp_f32 v89, v89
    v_exp_f32 v90, v90
    v_exp_f32 v91, v91
    v_smfmac_f32_32x32x32_bf16 v[48:63], v[36:39], v[80:87], v122
    s_mov_b64 exec, s[70:71]
    ds_read_b128 v[36:39], v121 offset:6144
    ds_read_b128 v[44:47], v121 offset:7168
    s_mov_b64 exec, -1
    v_exp_f32 v92, v92
    v_exp_f32 v93, v93
    v_mfma_f32_32x32x16_bf16 v[132:147], v[112:115], v[32:35], v[132:147]
    ds_read_b64_tr_b16 v[112:113], v5 offset:14336
    ds_read_b64_tr_b16 v[114:115], v5 offset:16128
    v_exp_f32 v94, v94
    s_cbranch_vccz SD_20
    v_mfma_f32_32x32x16_bf16 v[148:163], v[116:119], v[32:35], v[148:163]
    ds_read_b64_tr_b16 v[116:117], v6 offset:14336
    ds_read_b64_tr_b16 v[118:119], v6 offset:16128
SD_20:
    ds_read_b128 v[32:35], v4 offset:448
    v_exp_f32 v95, v95
    v_exp_f32 v96, v96
    v_exp_f32 v97, v97
    v_exp_f32 v98, v98
    v_smfmac_f32_32x32x32_bf16 v[48:63], v[40:43], v[88:95], v122
    s_setprio 0
    s_waitcnt lgkmcnt(0)
    v_exp_f32 v99, v99
    v_exp_f32 v100, v100
    v_exp_f32 v101, v101
    v_exp_f32 v102, v102
    v_mfma_f32_32x32x16_bf16 v[80:95], v[20:23], v[16:19], v[64:79]
    ds_read_b128 v[20:23], v120 offset:18432
    v_exp_f32 v103, v103
    v_exp_f32 v104, v104
    v_exp_f32 v105, v105
    v_exp_f32 v106, v106
    v_exp_f32 v107, v107
    v_smfmac_f32_32x32x32_bf16 v[48:63], v[36:39], v[96:103], v122
    s_mov_b64 exec, s[70:71]
    ds_read_b128 v[36:39], v121 offset:16384
    ds_read_b128 v[40:43], v121 offset:17408
    s_mov_b64 exec, -1
    v_exp_f32 v108, v108
    v_exp_f32 v109, v109
    v_mfma_f32_32x32x16_bf16 v[132:147], v[112:115], v[32:35], v[132:147]
    ds_read_b64_tr_b16 v[112:113], v5 offset:21504
    ds_read_b64_tr_b16 v[114:115], v5 offset:23296
    v_exp_f32 v110, v110
    s_cbranch_vccz SD_21
    v_mfma_f32_32x32x16_bf16 v[148:163], v[116:119], v[32:35], v[148:163]
    ds_read_b64_tr_b16 v[116:117], v6 offset:21504
    ds_read_b64_tr_b16 v[118:119], v6 offset:23296
SD_21:
    ds_read_b128 v[32:35], v4 offset:480
    v_exp_f32 v111, v111
    v_exp_f32 v80, v80
    v_exp_f32 v81, v81
    v_exp_f32 v82, v82
    v_smfmac_f32_32x32x32_bf16 v[48:63], v[44:47], v[104:111], v122
    s_waitcnt vmcnt(1) lgkmcnt(0)
    s_barrier
    s_setprio 3
    v_exp_f32 v83, v83
    v_exp_f32 v84, v84
    v_exp_f32 v85, v85
    v_exp_f32 v86, v86
    v_mfma_f32_32x32x16_bf16 v[96:111], v[20:23], v[16:19], v[64:79]
    ds_read_b128 v[20:23], v120 offset:20480
    s_add_u32 m0, s83, 0
    s_add_u32 s72, s82, 32768
    buffer_load_dwordx4 v3, s[44:47], s72 offen sc1 lds
    v_exp_f32 v87, v87
    v_exp_f32 v88, v88
    v_exp_f32 v89, v89
    v_exp_f32 v90, v90
    v_exp_f32 v91, v91
    v_smfmac_f32_32x32x32_bf16 v[48:63], v[36:39], v[80:87], v122
    s_mov_b64 exec, s[70:71]
    ds_read_b128 v[36:39], v121 offset:18432
    ds_read_b128 v[44:47], v121 offset:19456
    s_mov_b64 exec, -1
    s_add_u32 m0, s62, 99328
    s_nop 0
    buffer_load_dwordx4 v7, s[36:39], s61 offen lds
    v_exp_f32 v92, v92
    v_exp_f32 v93, v93
    v_mfma_f32_32x32x16_bf16 v[132:147], v[112:115], v[32:35], v[132:147]
    ds_read_b64_tr_b16 v[112:113], v5 offset:32768
    ds_read_b64_tr_b16 v[114:115], v5 offset:34560
    s_add_u32 m0, s63, 99328
    s_add_u32 s72, s61, 114688
    buffer_load_dwordx4 v8, s[36:39], s61 offen lds
    s_sub_u32 s61, s72, s38
    s_cselect_b32 s61, s72, s61
    v_exp_f32 v94, v94
    s_cbranch_vccz SD_22
    v_mfma_f32_32x32x16_bf16 v[148:163], v[116:119], v[32:35], v[148:163]
    ds_read_b64_tr_b16 v[116:117], v6 offset:32768
    ds_read_b64_tr_b16 v[118:119], v6 offset:34560
SD_22:
    ds_read_b128 v[32:35], v4 offset:512
    v_exp_f32 v95, v95
    v_exp_f32 v96, v96
    v_exp_f32 v97, v97
    v_exp_f32 v98, v98
    v_smfmac_f32_32x32x32_bf16 v[48:63], v[40:43], v[88:95], v122
    s_setprio 2
    s_waitcnt lgkmcnt(0)
    v_exp_f32 v99, v99
    v_exp_f32 v100, v100
    v_exp_f32 v101, v101
    v_exp_f32 v102, v102
    v_mfma_f32_32x32x16_bf16 v[80:95], v[20:23], v[16:19], v[64:79]
    ds_read_b128 v[20:23], v120 offset:22528
    v_exp_f32 v103, v103
    v_exp_f32 v104, v104
    v_exp_f32 v105, v105
    v_exp_f32 v106, v106
    v_exp_f32 v107, v107
    v_smfmac_f32_32x32x32_bf16 v[48:63], v[36:39], v[96:103], v122
    s_mov_b64 exec, s[70:71]
    ds_read_b128 v[36:39], v121 offset:20480
    ds_read_b128 v[40:43], v121 offset:21504
    s_mov_b64 exec, -1
    s_add_u32 m0, s62, 113664
    s_nop 0
    buffer_load_dwordx4 v7, s[36:39], s61 offen lds
    v_exp_f32 v108, v108
    v_exp_f32 v109, v109
    v_mfma_f32_32x32x16_bf16 v[132:147], v[112:115], v[32:35], v[132:147]
    ds_read_b64_tr_b16 v[112:113], v5 offset:39936
    ds_read_b64_tr_b16 v[114:115], v5 offset:41728
    s_add_u32 m0, s63, 113664
    s_add_u32 s72, s61, 114688
    buffer_load_dwordx4 v8, s[36:39], s61 offen lds
    s_sub_u32 s61, s72, s38
    s_cselect_b32 s61, s72, s61
    v_exp_f32 v110, v110
    s_cbranch_vccz SD_23
    v_mfma_f32_32x32x16_bf16 v[148:163], v[116:119], v[32:35], v[148:163]
    ds_read_b64_tr_b16 v[116:117], v6 offset:39936
    ds_read_b64_tr_b16 v[118:119], v6 offset:41728
SD_23:
    ds_read_b128 v[32:35], v4 offset:544
    v_exp_f32 v111, v111
    v_exp_f32 v80, v80
    v_exp_f32 v81, v81
    v_exp_f32 v82, v82
    v_smfmac_f32_32x32x32_bf16 v[48:63], v[44:47], v[104:111], v122
    s_setprio 1
    s_waitcnt lgkmcnt(0)
    v_exp_f32 v83, v83
    v_exp_f32 v84, v84
    v_exp_f32 v85, v85
    v_exp_f32 v86, v86
    v_mfma_f32_32x32x16_bf16 v[96:111], v[20:23], v[16:19], v[64:79]
    ds_read_b128 v[20:23], v120 offset:8192
    v_exp_f32 v87, v87
    v_exp_f32 v88, v88
    v_exp_f32 v89, v89
    v_exp_f32 v90, v90
    v_exp_f32 v91, v91
    v_smfmac_f32_32x32x32_bf16 v[48:63], v[36:39], v[80:87], v122
    s_mov_b64 exec, s[70:71]
    ds_read_b128 v[36:39], v121 offset:22528
    ds_read_b128 v[44:47], v121 offset:23552
    s_mov_b64 exec, -1
    v_exp_f32 v92, v92
    v_exp_f32 v93, v93
    v_mfma_f32_32x32x16_bf16 v[132:147], v[112:115], v[32:35], v[132:147]
    ds_read_b64_tr_b16 v[112:113], v5 offset:47104
    ds_read_b64_tr_b16 v[114:115], v5 offset:48896
    v_exp_f32 v94, v94
    s_cbranch_vccz SD_24
    v_mfma_f32_32x32x16_bf16 v[148:163], v[116:119], v[32:35], v[148:163]
    ds_read_b64_tr_b16 v[116:117], v6 offset:47104
    ds_read_b64_tr_b16 v[118:119], v6 offset:48896
SD_24:
    ds_read_b128 v[32:35], v4 offset:576
    v_exp_f32 v95, v95
    v_exp_f32 v96, v96
    v_exp_f32 v97, v97
    v_exp_f32 v98, v98
    v_smfmac_f32_32x32x32_bf16 v[48:63], v[40:43], v[88:95], v122
    s_setprio 0
    s_waitcnt lgkmcnt(0)
    v_exp_f32 v99, v99
    v_exp_f32 v100, v100
    v_exp_f32 v101, v101
    v_exp_f32 v102, v102
    v_mfma_f32_32x32x16_bf16 v[80:95], v[20:23], v[16:19], v[64:79]
    ds_read_b128 v[20:23], v120 offset:10240
    v_exp_f32 v103, v103
    v_exp_f32 v104, v104
    v_exp_f32 v105, v105
    v_exp_f32 v106, v106
    v_exp_f32 v107, v107
    v_smfmac_f32_32x32x32_bf16 v[48:63], v[36:39], v[96:103], v122
    s_mov_b64 exec, s[70:71]
    ds_read_b128 v[36:39], v121 offset:8192
    ds_read_b128 v[40:43], v121 offset:9216
    s_mov_b64 exec, -1
    v_exp_f32 v108, v108
    v_exp_f32 v109, v109
    v_mfma_f32_32x32x16_bf16 v[132:147], v[112:115], v[32:35], v[132:147]
    ds_read_b64_tr_b16 v[112:113], v5 offset:54272
    ds_read_b64_tr_b16 v[114:115], v5 offset:56064
    v_exp_f32 v110, v110
    s_cbranch_vccz SD_25
    v_mfma_f32_32x32x16_bf16 v[148:163], v[116:119], v[32:35], v[148:163]
    ds_read_b64_tr_b16 v[116:117], v6 offset:54272
    ds_read_b64_tr_b16 v[118:119], v6 offset:56064
SD_25:
    ds_read_b128 v[32:35], v4 offset:608
    v_exp_f32 v111, v111
    v_exp_f32 v80, v80
    v_exp_f32 v81, v81
    v_exp_f32 v82, v82
    v_smfmac_f32_32x32x32_bf16 v[48:63], v[44:47], v[104:111], v122
    s_waitcnt vmcnt(0) lgkmcnt(0)
    s_barrier
    s_setprio 3
    v_exp_f32 v83, v83
    v_exp_f32 v84, v84
    v_exp_f32 v85, v85
    v_exp_f32 v86, v86
    v_mfma_f32_32x32x16_bf16 v[96:111], v[20:23], v[16:19], v[64:79]
    ds_read_b128 v[20:23], v120 offset:12288
    s_add_u32 m0, s83, 16384
    s_add_u32 s72, s82, 40960
    buffer_load_dwordx4 v3, s[44:47], s72 offen sc1 lds
    v_exp_f32 v87, v87
    v_exp_f32 v88, v88
    v_exp_f32 v89, v89
    v_exp_f32 v90, v90
    v_exp_f32 v91, v91
    v_smfmac_f32_32x32x32_bf16 v[48:63], v[36:39], v[80:87], v122
    s_mov_b64 exec, s[70:71]
    ds_read_b128 v[36:39], v121 offset:10240
    ds_read_b128 v[44:47], v121 offset:11264
    s_mov_b64 exec, -1
    s_add_u32 m0, s62, 132096
    s_nop 0
    buffer_load_dwordx4 v7, s[36:39], s61 offen lds
    v_exp_f32 v92, v92
    v_exp_f32 v93, v93
    v_mfma_f32_32x32x16_bf16 v[132:147], v[112:115], v[32:35], v[132:147]
    ds_read_b64_tr_b16 v[112:113], v5 offset:0
    ds_read_b64_tr_b16 v[114:115], v5 offset:1792
    s_add_u32 m0, s63, 132096
    s_add_u32 s72, s61, 114688
    buffer_load_dwordx4 v8, s[36:39], s61 offen lds
    s_sub_u32 s61, s72, s38
    s_cselect_b32 s61, s72, s61
    v_exp_f32 v94, v94
    s_cbranch_vccz SD_26
    v_mfma_f32_32x32x16_bf16 v[148:163], v[116:119], v[32:35], v[148:163]
    ds_read_b64_tr_b16 v[116:117], v6 offset:0
    ds_read_b64_tr_b16 v[118:119], v6 offset:1792
SD_26:
    ds_read_b128 v[32:35], v4 offset:640
    v_exp_f32 v95, v95
    v_exp_f32 v96, v96
    v_exp_f32 v97, v97
    v_exp_f32 v98, v98
    v_smfmac_f32_32x32x32_bf16 v[48:63], v[40:43], v[88:95], v122
    s_setprio 2
    s_waitcnt lgkmcnt(0)
    v_exp_f32 v99, v99
    v_exp_f32 v100, v100
    v_exp_f32 v101, v101
    v_exp_f32 v102, v102
    v_mfma_f32_32x32x16_bf16 v[80:95], v[20:23], v[16:19], v[64:79]
    ds_read_b128 v[20:23], v120 offset:14336
    v_exp_f32 v103, v103
    v_exp_f32 v104, v104
    v_exp_f32 v105, v105
    v_exp_f32 v106, v106
    v_exp_f32 v107, v107
    v_smfmac_f32_32x32x32_bf16 v[48:63], v[36:39], v[96:103], v122
    s_mov_b64 exec, s[70:71]
    ds_read_b128 v[36:39], v121 offset:12288
    ds_read_b128 v[40:43], v121 offset:13312
    s_mov_b64 exec, -1
    s_add_u32 m0, s62, 146432
    s_nop 0
    buffer_load_dwordx4 v7, s[36:39], s61 offen lds
    v_exp_f32 v108, v108
    v_exp_f32 v109, v109
    v_mfma_f32_32x32x16_bf16 v[132:147], v[112:115], v[32:35], v[132:147]
    ds_read_b64_tr_b16 v[112:113], v5 offset:7168
    ds_read_b64_tr_b16 v[114:115], v5 offset:8960
    s_add_u32 m0, s63, 146432
    s_add_u32 s72, s61, 114688
    buffer_load_dwordx4 v8, s[36:39], s61 offen lds
    s_sub_u32 s61, s72, s38
    s_cselect_b32 s61, s72, s61
    v_exp_f32 v110, v110
    s_cbranch_vccz SD_27
    v_mfma_f32_32x32x16_bf16 v[148:163], v[116:119], v[32:35], v[148:163]
    ds_read_b64_tr_b16 v[116:117], v6 offset:7168
    ds_read_b64_tr_b16 v[118:119], v6 offset:8960
SD_27:
    ds_read_b128 v[32:35], v4 offset:672
    v_exp_f32 v111, v111
    v_exp_f32 v80, v80
    v_exp_f32 v81, v81
    v_exp_f32 v82, v82
    v_smfmac_f32_32x32x32_bf16 v[48:63], v[44:47], v[104:111], v122
    s_setprio 1
    s_waitcnt lgkmcnt(0)
    v_exp_f32 v83, v83
    v_exp_f32 v84, v84
    v_exp_f32 v85, v85
    v_exp_f32 v86, v86
    v_mfma_f32_32x32x16_bf16 v[96:111], v[20:23], v[16:19], v[64:79]
    ds_read_b128 v[20:23], v120 offset:24576
    v_exp_f32 v87, v87
    v_exp_f32 v88, v88
    v_exp_f32 v89, v89
    v_exp_f32 v90, v90
    v_exp_f32 v91, v91
    v_smfmac_f32_32x32x32_bf16 v[48:63], v[36:39], v[80:87], v122
    s_mov_b64 exec, s[70:71]
    ds_read_b128 v[36:39], v121 offset:14336
    ds_read_b128 v[44:47], v121 offset:15360
    s_mov_b64 exec, -1
    v_exp_f32 v92, v92
    v_exp_f32 v93, v93
    v_mfma_f32_32x32x16_bf16 v[132:147], v[112:115], v[32:35], v[132:147]
    ds_read_b64_tr_b16 v[112:113], v5 offset:14336
    ds_read_b64_tr_b16 v[114:115], v5 offset:16128
    v_exp_f32 v94, v94
    s_cbranch_vccz SD_28
    v_mfma_f32_32x32x16_bf16 v[148:163], v[116:119], v[32:35], v[148:163]
    ds_read_b64_tr_b16 v[116:117], v6 offset:14336
    ds_read_b64_tr_b16 v[118:119], v6 offset:16128
SD_28:
    ds_read_b128 v[32:35], v4 offset:704
    v_exp_f32 v95, v95
    v_exp_f32 v96, v96
    v_exp_f32 v97, v97
    v_exp_f32 v98, v98
    v_smfmac_f32_32x32x32_bf16 v[48:63], v[40:43], v[88:95], v122
    s_setprio 0
    s_waitcnt lgkmcnt(0)
    v_exp_f32 v99, v99
    v_exp_f32 v100, v100
    v_exp_f32 v101, v101
    v_exp_f32 v102, v102
    v_mfma_f32_32x32x16_bf16 v[80:95], v[20:23], v[16:19], v[64:79]
    ds_read_b128 v[20:23], v120 offset:26624
    v_exp_f32 v103, v103
    v_exp_f32 v104, v104
    v_exp_f32 v105, v105
    v_exp_f32 v106, v106
    v_exp_f32 v107, v107
    v_smfmac_f32_32x32x32_bf16 v[48:63], v[36:39], v[96:103], v122
    s_mov_b64 exec, s[70:71]
    ds_read_b128 v[36:39], v121 offset:24576
    ds_read_b128 v[40:43], v121 offset:25600
    s_mov_b64 exec, -1
    v_exp_f32 v108, v108
    v_exp_f32 v109, v109
    v_mfma_f32_32x32x16_bf16 v[132:147], v[112:115], v[32:35], v[132:147]
    ds_read_b64_tr_b16 v[112:113], v5 offset:21504
    ds_read_b64_tr_b16 v[114:115], v5 offset:23296
    v_exp_f32 v110, v110
    s_cbranch_vccz SD_29
    v_mfma_f32_32x32x16_bf16 v[148:163], v[116:119], v[32:35], v[148:163]
    ds_read_b64_tr_b16 v[116:117], v6 offset:21504
    ds_read_b64_tr_b16 v[118:119], v6 offset:23296
SD_29:
    ds_read_b128 v[32:35], v4 offset:736
    v_exp_f32 v111, v111
    v_exp_f32 v80, v80
    v_exp_f32 v81, v81
    v_exp_f32 v82, v82
    v_smfmac_f32_32x32x32_bf16 v[48:63], v[44:47], v[104:111], v122
    s_waitcnt vmcnt(0) lgkmcnt(0)
    s_barrier
    s_setprio 3
    v_exp_f32 v83, v83
    v_exp_f32 v84, v84
    v_exp_f32 v85, v85
    v_exp_f32 v86, v86
    v_mfma_f32_32x32x16_bf16 v[96:111], v[20:23], v[16:19], v[64:79]
    ds_read_b128 v[20:23], v120 offset:28672
    s_add_u32 m0, s83, 8192
    s_add_u32 s72, s82, 49152
    buffer_load_dwordx4 v3, s[44:47], s72 offen sc1 lds
    v_exp_f32 v87, v87
    v_exp_f32 v88, v88
    v_exp_f32 v89, v89
    v_exp_f32 v90, v90
    v_exp_f32 v91, v91
    v_smfmac_f32_32x32x32_bf16 v[48:63], v[36:39], v[80:87], v122
    s_mov_b64 exec, s[70:71]
    ds_read_b128 v[36:39], v121 offset:26624
    ds_read_b128 v[44:47], v121 offset:27648
    s_mov_b64 exec, -1
    s_add_u32 m0, s62, 99328
    s_nop 0
    buffer_load_dwordx4 v7, s[36:39], s61 offen lds
    v_exp_f32 v92, v92
    v_exp_f32 v93, v93
    v_mfma_f32_32x32x16_bf16 v[132:147], v[112:115], v[32:35], v[132:147]
    ds_read_b64_tr_b16 v[112:113], v5 offset:32768
    ds_read_b64_tr_b16 v[114:115], v5 offset:34560
    s_add_u32 m0, s63, 99328
    s_add_u32 s72, s61, 114688
    buffer_load_dwordx4 v8, s[36:39], s61 offen lds
    s_sub_u32 s61, s72, s38
    s_cselect_b32 s61, s72, s61
    v_exp_f32 v94, v94
    s_cbranch_vccz SD_30
    v_mfma_f32_32x32x16_bf16 v[148:163], v[116:119], v[32:35], v[148:163]
    ds_read_b64_tr_b16 v[116:117], v6 offset:32768
    ds_read_b64_tr_b16 v[118:119], v6 offset:34560
SD_30:
    ds_read_b128 v[32:35], v4 offset:768
    v_exp_f32 v95, v95
    v_exp_f32 v96, v96
    v_exp_f32 v97, v97
    v_exp_f32 v98, v98
    v_smfmac_f32_32x32x32_bf16 v[48:63], v[40:43], v[88:95], v122
    s_setprio 2
    s_waitcnt lgkmcnt(0)
    v_exp_f32 v99, v99
    v_exp_f32 v100, v100
    v_exp_f32 v101, v101
    v_exp_f32 v102, v102
    v_mfma_f32_32x32x16_bf16 v[80:95], v[20:23], v[16:19], v[64:79]
    ds_read_b128 v[20:23], v120 offset:30720
    v_exp_f32 v103, v103
    v_exp_f32 v104, v104
    v_exp_f32 v105, v105
    v_exp_f32 v106, v106
    v_exp_f32 v107, v107
    v_smfmac_f32_32x32x32_bf16 v[48:63], v[36:39], v[96:103], v122
    s_mov_b64 exec, s[70:71]
    ds_read_b128 v[36:39], v121 offset:28672
    ds_read_b128 v[40:43], v121 offset:29696
    s_mov_b64 exec, -1
    s_add_u32 m0, s62, 113664
    s_nop 0
    buffer_load_dwordx4 v7, s[36:39], s61 offen lds
    v_exp_f32 v108, v108
    v_exp_f32 v109, v109
    v_mfma_f32_32x32x16_bf16 v[132:147], v[112:115], v[32:35], v[132:147]
    ds_read_b64_tr_b16 v[112:113], v5 offset:39936
    ds_read_b64_tr_b16 v[114:115], v5 offset:41728
    s_add_u32 m0, s63, 113664
    s_add_u32 s72, s61, 114688
    buffer_load_dwordx4 v8, s[36:39], s61 offen lds
    s_sub_u32 s61, s72, s38
    s_cselect_b32 s61, s72, s61
    v_exp_f32 v110, v110
    s_cbranch_vccz SD_31
    v_mfma_f32_32x32x16_bf16 v[148:163], v[116:119], v[32:35], v[148:163]
    ds_read_b64_tr_b16 v[116:117], v6 offset:39936
    ds_read_b64_tr_b16 v[118:119], v6 offset:41728
SD_31:
    ds_read_b128 v[32:35], v4 offset:800
    v_exp_f32 v111, v111
    v_exp_f32 v80, v80
    v_exp_f32 v81, v81
    v_exp_f32 v82, v82
    v_smfmac_f32_32x32x32_bf16 v[48:63], v[44:47], v[104:111], v122
    s_setprio 1
    s_waitcnt lgkmcnt(0)
    v_exp_f32 v83, v83
    v_exp_f32 v84, v84
    v_exp_f32 v85, v85
    v_exp_f32 v86, v86
    v_mfma_f32_32x32x16_bf16 v[96:111], v[20:23], v[16:19], v[64:79]
    ds_read_b128 v[20:23], v120 offset:0
    v_exp_f32 v87, v87
    v_exp_f32 v88, v88
    v_exp_f32 v89, v89
    v_exp_f32 v90, v90
    v_exp_f32 v91, v91
    v_smfmac_f32_32x32x32_bf16 v[48:63], v[36:39], v[80:87], v122
    s_mov_b64 exec, s[70:71]
    ds_read_b128 v[36:39], v121 offset:30720
    ds_read_b128 v[44:47], v121 offset:31744
    s_mov_b64 exec, -1
    v_exp_f32 v92, v92
    v_exp_f32 v93, v93
    v_mfma_f32_32x32x16_bf16 v[132:147], v[112:115], v[32:35], v[132:147]
    ds_read_b64_tr_b16 v[112:113], v5 offset:47104
    ds_read_b64_tr_b16 v[114:115], v5 offset:48896
    v_exp_f32 v94, v94
    s_cbranch_vccz SD_32
    v_mfma_f32_32x32x16_bf16 v[148:163], v[116:119], v[32:35], v[148:163]
    ds_read_b64_tr_b16 v[116:117], v6 offset:47104
    ds_read_b64_tr_b16 v[118:119], v6 offset:48896
SD_32:
    ds_read_b128 v[32:35], v4 offset:832
    v_exp_f32 v95, v95
    v_exp_f32 v96, v96
    v_exp_f32 v97, v97
    v_exp_f32 v98, v98
    v_smfmac_f32_32x32x32_bf16 v[48:63], v[40:43], v[88:95], v122
    s_setprio 0
    s_waitcnt lgkmcnt(0)
    v_exp_f32 v99, v99
    v_exp_f32 v100, v100
    v_exp_f32 v101, v101
    v_exp_f32 v102, v102
    v_mfma_f32_32x32x16_bf16 v[80:95], v[20:23], v[16:19], v[64:79]
    ds_read_b128 v[20:23], v120 offset:2048
    v_exp_f32 v103, v103
    v_exp_f32 v104, v104
    v_exp_f32 v105, v105
    v_exp_f32 v106, v106
    v_exp_f32 v107, v107
    v_smfmac_f32_32x32x32_bf16 v[48:63], v[36:39], v[96:103], v122
    s_mov_b64 exec, s[70:71]
    ds_read_b128 v[36:39], v121 offset:0
    ds_read_b128 v[40:43], v121 offset:1024
    s_mov_b64 exec, -1
    v_exp_f32 v108, v108
    v_exp_f32 v109, v109
    v_mfma_f32_32x32x16_bf16 v[132:147], v[112:115], v[32:35], v[132:147]
    ds_read_b64_tr_b16 v[112:113], v5 offset:54272
    ds_read_b64_tr_b16 v[114:115], v5 offset:56064
    v_exp_f32 v110, v110
    s_cbranch_vccz SD_33
    v_mfma_f32_32x32x16_bf16 v[148:163], v[116:119], v[32:35], v[148:163]
    ds_read_b64_tr_b16 v[116:117], v6 offset:54272
    ds_read_b64_tr_b16 v[118:119], v6 offset:56064
SD_33:
    ds_read_b128 v[32:35], v4 offset:864
    v_exp_f32 v111, v111
    v_exp_f32 v80, v80
    v_exp_f32 v81, v81
    v_exp_f32 v82, v82
    v_smfmac_f32_32x32x32_bf16 v[48:63], v[44:47], v[104:111], v122
    s_waitcnt vmcnt(0) lgkmcnt(0)
    s_barrier
    s_setprio 3
    v_exp_f32 v83, v83
    v_exp_f32 v84, v84
    v_exp_f32 v85, v85
    v_exp_f32 v86, v86
    v_mfma_f32_32x32x16_bf16 v[96:111], v[20:23], v[16:19], v[64:79]
    ds_read_b128 v[20:23], v120 offset:4096
    v_exp_f32 v87, v87
    v_exp_f32 v88, v88
    v_exp_f32 v89, v89
    v_exp_f32 v90, v90
    v_exp_f32 v91, v91
    v_smfmac_f32_32x32x32_bf16 v[48:63], v[36:39], v[80:87], v122
    s_mov_b64 exec, s[70:71]
    ds_read_b128 v[36:39], v121 offset:2048
    ds_read_b128 v[44:47], v121 offset:3072
    s_mov_b64 exec, -1
    s_add_u32 m0, s83, 24576
    s_add_u32 s72, s82, 57344
    buffer_load_dwordx4 v3, s[44:47], s72 offen sc1 lds
    v_exp_f32 v92, v92
    v_exp_f32 v93, v93
    v_mfma_f32_32x32x16_bf16 v[132:147], v[112:115], v[32:35], v[132:147]
    ds_read_b64_tr_b16 v[112:113], v5 offset:0
    ds_read_b64_tr_b16 v[114:115], v5 offset:1792
    s_lshr_b32 s72, s27, 2
    s_lshl_b32 s72, s72, 9
    s_cmp_eq_u32 s28, 7
    s_cbranch_scc1 T3_34
    s_lshl_b32 s73, s28, 5
    s_add_u32 s73, s73, s69
    s_lshl_b32 s73, s73, 13
    s_add_u32 s72, s72, s73
    s_mov_b32 exec_hi, 0
    buffer_load_dword v255, v127, s[48:51], s72 offen
    s_mov_b64 exec, -1
    s_branch T3_35
T3_34:
    s_lshl_b32 s73, s69, 14
    s_add_u32 s72, s72, s73
    buffer_load_dword v255, v127, s[52:55], s72 offen
T3_35:
    v_exp_f32 v94, v94
    s_cbranch_vccz SD_36
    v_mfma_f32_32x32x16_bf16 v[148:163], v[116:119], v[32:35], v[148:163]
    ds_read_b64_tr_b16 v[116:117], v6 offset:0
    ds_read_b64_tr_b16 v[118:119], v6 offset:1792
SD_36:
    ds_read_b128 v[32:35], v4 offset:896
    v_exp_f32 v95, v95
    v_exp_f32 v96, v96
    v_exp_f32 v97, v97
    v_exp_f32 v98, v98
    v_smfmac_f32_32x32x32_bf16 v[48:63], v[40:43], v[88:95], v122
    s_setprio 2
    s_waitcnt lgkmcnt(0)
    v_exp_f32 v99, v99
    v_exp_f32 v100, v100
    v_exp_f32 v101, v101
    v_exp_f32 v102, v102
    v_mfma_f32_32x32x16_bf16 v[80:95], v[20:23], v[16:19], v[64:79]
    ds_read_b128 v[20:23], v120 offset:6144
    v_exp_f32 v103, v103
    v_exp_f32 v104, v104
    v_exp_f32 v105, v105
    v_exp_f32 v106, v106
    v_exp_f32 v107, v107
    v_smfmac_f32_32x32x32_bf16 v[48:63], v[36:39], v[96:103], v122
    s_mov_b64 exec, s[70:71]
    ds_read_b128 v[36:39], v121 offset:4096
    ds_read_b128 v[40:43], v121 offset:5120
    s_mov_b64 exec, -1
    v_exp_f32 v108, v108
    v_exp_f32 v109, v109
    v_mfma_f32_32x32x16_bf16 v[132:147], v[112:115], v[32:35], v[132:147]
    ds_read_b64_tr_b16 v[112:113], v5 offset:7168
    ds_read_b64_tr_b16 v[114:115], v5 offset:8960
    v_exp_f32 v110, v110
    s_cbranch_vccz SD_37
    v_mfma_f32_32x32x16_bf16 v[148:163], v[116:119], v[32:35], v[148:163]
    ds_read_b64_tr_b16 v[116:117], v6 offset:7168
    ds_read_b64_tr_b16 v[118:119], v6 offset:8960
SD_37:
    ds_read_b128 v[32:35], v4 offset:928
    v_exp_f32 v111, v111
    v_exp_f32 v80, v80
    v_exp_f32 v81, v81
    v_exp_f32 v82, v82
    v_smfmac_f32_32x32x32_bf16 v[48:63], v[44:47], v[104:111], v122
    s_setprio 1
    s_waitcnt lgkmcnt(0)
    v_exp_f32 v83, v83
    v_exp_f32 v84, v84
    v_exp_f32 v85, v85
    v_exp_f32 v86, v86
    v_mfma_f32_32x32x16_bf16 v[96:111], v[20:23], v[16:19], v[64:79]
    ds_read_b128 v[20:23], v120 offset:16384
    v_exp_f32 v87, v87
    v_exp_f32 v88, v88
    v_exp_f32 v89, v89
    v_exp_f32 v90, v90
    v_exp_f32 v91, v91
    v_smfmac_f32_32x32x32_bf16 v[48:63], v[36:39], v[80:87], v122
    s_mov_b64 exec, s[70:71]
    ds_read_b128 v[36:39], v121 offset:6144
    ds_read_b128 v[44:47], v121 offset:7168
    s_mov_b64 exec, -1
    v_exp_f32 v92, v92
    v_exp_f32 v93, v93
    v_mfma_f32_32x32x16_bf16 v[132:147], v[112:115], v[32:35], v[132:147]
    ds_read_b64_tr_b16 v[112:113], v5 offset:14336
    ds_read_b64_tr_b16 v[114:115], v5 offset:16128
    v_exp_f32 v94, v94
    s_cbranch_vccz SD_38
    v_mfma_f32_32x32x16_bf16 v[148:163], v[116:119], v[32:35], v[148:163]
    ds_read_b64_tr_b16 v[116:117], v6 offset:14336
    ds_read_b64_tr_b16 v[118:119], v6 offset:16128
SD_38:
    ds_read_b128 v[32:35], v4 offset:960
    v_exp_f32 v95, v95
    v_exp_f32 v96, v96
    v_exp_f32 v97, v97
    v_exp_f32 v98, v98
    v_smfmac_f32_32x32x32_bf16 v[48:63], v[40:43], v[88:95], v122
    s_setprio 0
    s_waitcnt lgkmcnt(0)
    v_exp_f32 v99, v99
    v_exp_f32 v100, v100
    v_exp_f32 v101, v101
    v_exp_f32 v102, v102
    v_mfma_f32_32x32x16_bf16 v[80:95], v[20:23], v[16:19], v[64:79]
    ds_read_b128 v[20:23], v120 offset:18432
    v_exp_f32 v103, v103
    v_exp_f32 v104, v104
    v_exp_f32 v105, v105
    v_exp_f32 v106, v106
    v_exp_f32 v107, v107
    v_smfmac_f32_32x32x32_bf16 v[48:63], v[36:39], v[96:103], v122
    s_mov_b64 exec, s[70:71]
    ds_read_b128 v[36:39], v121 offset:16384
    ds_read_b128 v[40:43], v121 offset:17408
    s_mov_b64 exec, -1
    v_exp_f32 v108, v108
    v_exp_f32 v109, v109
    v_mfma_f32_32x32x16_bf16 v[132:147], v[112:115], v[32:35], v[132:147]
    ds_read_b64_tr_b16 v[112:113], v5 offset:21504
    ds_read_b64_tr_b16 v[114:115], v5 offset:23296
    v_exp_f32 v110, v110
    s_cbranch_vccz SD_39
    v_mfma_f32_32x32x16_bf16 v[148:163], v[116:119], v[32:35], v[148:163]
    ds_read_b64_tr_b16 v[116:117], v6 offset:21504
    ds_read_b64_tr_b16 v[118:119], v6 offset:23296
SD_39:
    ds_read_b128 v[32:35], v4 offset:992
    v_exp_f32 v111, v111
    v_exp_f32 v80, v80
    v_exp_f32 v81, v81
    v_exp_f32 v82, v82
    v_smfmac_f32_32x32x32_bf16 v[48:63], v[44:47], v[104:111], v122
    s_waitcnt lgkmcnt(0)
    s_barrier
    s_setprio 3
    v_exp_f32 v83, v83
    v_exp_f32 v84, v84
    v_exp_f32 v85, v85
    v_exp_f32 v86, v86
    v_mfma_f32_32x32x16_bf16 v[96:111], v[20:23], v[16:19], v[64:79]
    ds_read_b128 v[20:23], v120 offset:20480
    v_exp_f32 v87, v87
    v_exp_f32 v88, v88
    v_exp_f32 v89, v89
    v_exp_f32 v90, v90
    v_exp_f32 v91, v91
    v_smfmac_f32_32x32x32_bf16 v[48:63], v[36:39], v[80:87], v122
    s_mov_b64 exec, s[70:71]
    ds_read_b128 v[36:39], v121 offset:18432
    ds_read_b128 v[44:47], v121 offset:19456
    s_mov_b64 exec, -1
    s_add_u32 m0, s83, 0
    s_add_u32 s72, s82, 65536
    buffer_load_dwordx4 v3, s[44:47], s72 offen sc1 lds
    v_exp_f32 v92, v92
    v_exp_f32 v93, v93
    v_mfma_f32_32x32x16_bf16 v[132:147], v[112:115], v[32:35], v[132:147]
    v_exp_f32 v94, v94
    s_cbranch_vccz SD_40
    v_mfma_f32_32x32x16_bf16 v[148:163], v[116:119], v[32:35], v[148:163]
SD_40:
    v_exp_f32 v95, v95
    v_exp_f32 v96, v96
    v_exp_f32 v97, v97
    v_exp_f32 v98, v98
    v_smfmac_f32_32x32x32_bf16 v[48:63], v[40:43], v[88:95], v122
    s_setprio 2
    s_waitcnt lgkmcnt(0)
    v_exp_f32 v99, v99
    v_exp_f32 v100, v100
    v_exp_f32 v101, v101
    v_exp_f32 v102, v102
    v_mfma_f32_32x32x16_bf16 v[80:95], v[20:23], v[16:19], v[64:79]
    ds_read_b128 v[20:23], v120 offset:22528
    v_exp_f32 v103, v103
    v_exp_f32 v104, v104
    v_exp_f32 v105, v105
    v_exp_f32 v106, v106
    v_exp_f32 v107, v107
    v_smfmac_f32_32x32x32_bf16 v[48:63], v[36:39], v[96:103], v122
    s_mov_b64 exec, s[70:71]
    ds_read_b128 v[36:39], v121 offset:20480
    ds_read_b128 v[40:43], v121 offset:21504
    s_mov_b64 exec, -1
    v_exp_f32 v108, v108
    v_exp_f32 v109, v109
    v_exp_f32 v110, v110
    v_exp_f32 v111, v111
    v_pk_mul_f32 v[132:133], v[132:133], v[12:13]
    v_pk_mul_f32 v[134:135], v[134:135], v[12:13]
    v_pk_mul_f32 v[136:137], v[136:137], v[12:13]
    v_pk_mul_f32 v[138:139], v[138:139], v[12:13]
    v_pk_mul_f32 v[140:141], v[140:141], v[12:13]
    v_pk_mul_f32 v[142:143], v[142:143], v[12:13]
    v_pk_mul_f32 v[144:145], v[144:145], v[12:13]
    v_pk_mul_f32 v[146:147], v[146:147], v[12:13]
    v_cvt_pk_bf16_f32 v132, v132, v133
    v_cvt_pk_bf16_f32 v133, v134, v135
    v_cvt_pk_bf16_f32 v134, v136, v137
    v_cvt_pk_bf16_f32 v135, v138, v139
    v_cvt_pk_bf16_f32 v136, v140, v141
    v_cvt_pk_bf16_f32 v137, v142, v143
    v_cvt_pk_bf16_f32 v138, v144, v145
    v_cvt_pk_bf16_f32 v139, v146, v147
    v_pk_max_i16 v132, v132, 0
    v_pk_max_i16 v133, v133, 0
    v_pk_max_i16 v134, v134, 0
    v_pk_max_i16 v135, v135, 0
    v_pk_max_i16 v136, v136, 0
    v_pk_max_i16 v137, v137, 0
    v_pk_max_i16 v138, v138, 0
    v_pk_max_i16 v139, v139, 0
    buffer_store_dwordx4 v[132:135], v3, s[44:47], s64 offen offset:0 sc1
    v_exp_f32 v80, v80
    v_exp_f32 v81, v81
    v_exp_f32 v82, v82
    v_smfmac_f32_32x32x32_bf16 v[48:63], v[44:47], v[104:111], v122
    s_setprio 1
    s_waitcnt lgkmcnt(0)
    v_exp_f32 v83, v83
    v_exp_f32 v84, v84
    v_exp_f32 v85, v85
    v_exp_f32 v86, v86
    v_mfma_f32_32x32x16_bf16 v[96:111], v[20:23], v[16:19], v[64:79]
    ds_read_b128 v[20:23], v120 offset:8192
    v_exp_f32 v87, v87
    v_exp_f32 v88, v88
    v_exp_f32 v89, v89
    v_exp_f32 v90, v90
    v_exp_f32 v91, v91
    v_smfmac_f32_32x32x32_bf16 v[48:63], v[36:39], v[80:87], v122
    s_mov_b64 exec, s[70:71]
    ds_read_b128 v[36:39], v121 offset:22528
    ds_read_b128 v[44:47], v121 offset:23552
    s_mov_b64 exec, -1
    v_exp_f32 v92, v92
    v_exp_f32 v93, v93
    v_exp_f32 v94, v94
    v_exp_f32 v95, v95
    v_pk_mul_f32 v[148:149], v[148:149], v[12:13]
    v_pk_mul_f32 v[150:151], v[150:151], v[12:13]
    v_pk_mul_f32 v[152:153], v[152:153], v[12:13]
    v_pk_mul_f32 v[154:155], v[154:155], v[12:13]
    v_pk_mul_f32 v[156:157], v[156:157], v[12:13]
    v_pk_mul_f32 v[158:159], v[158:159], v[12:13]
    v_pk_mul_f32 v[160:161], v[160:161], v[12:13]
    v_pk_mul_f32 v[162:163], v[162:163], v[12:13]
    v_cvt_pk_bf16_f32 v148, v148, v149
    v_cvt_pk_bf16_f32 v149, v150, v151
    v_cvt_pk_bf16_f32 v150, v152, v153
    v_cvt_pk_bf16_f32 v151, v154, v155
    v_cvt_pk_bf16_f32 v152, v156, v157
    v_cvt_pk_bf16_f32 v153, v158, v159
    v_cvt_pk_bf16_f32 v154, v160, v161
    v_cvt_pk_bf16_f32 v155, v162, v163
    v_pk_max_i16 v148, v148, 0
    v_pk_max_i16 v149, v149, 0
    v_pk_max_i16 v150, v150, 0
    v_pk_max_i16 v151, v151, 0
    v_pk_max_i16 v152, v152, 0
    v_pk_max_i16 v153, v153, 0
    v_pk_max_i16 v154, v154, 0
    v_pk_max_i16 v155, v155, 0
    v_exp_f32 v96, v96
    v_exp_f32 v97, v97
    v_exp_f32 v98, v98
    v_smfmac_f32_32x32x32_bf16 v[48:63], v[40:43], v[88:95], v122
    s_setprio 0
    s_waitcnt lgkmcnt(0)
    v_exp_f32 v99, v99
    v_exp_f32 v100, v100
    v_exp_f32 v101, v101
    v_exp_f32 v102, v102
    v_mfma_f32_32x32x16_bf16 v[80:95], v[20:23], v[16:19], v[64:79]
    ds_read_b128 v[20:23], v120 offset:10240
    v_exp_f32 v103, v103
    v_exp_f32 v104, v104
    v_exp_f32 v105, v105
    v_exp_f32 v106, v106
    v_exp_f32 v107, v107
    v_smfmac_f32_32x32x32_bf16 v[48:63], v[36:39], v[96:103], v122
    s_mov_b64 exec, s[70:71]
    ds_read_b128 v[36:39], v121 offset:8192
    ds_read_b128 v[40:43], v121 offset:9216
    s_mov_b64 exec, -1
    v_exp_f32 v108, v108
    v_exp_f32 v109, v109
    v_exp_f32 v110, v110
    v_exp_f32 v111, v111
    buffer_store_dwordx4 v[136:139], v3, s[44:47], s64 offen offset:1024 sc1
    v_exp_f32 v80, v80
    v_exp_f32 v81, v81
    v_exp_f32 v82, v82
    v_smfmac_f32_32x32x32_bf16 v[48:63], v[44:47], v[104:111], v122
    s_waitcnt vmcnt(4) lgkmcnt(0)
    s_barrier
    s_setprio 3
    v_exp_f32 v83, v83
    v_exp_f32 v84, v84
    v_exp_f32 v85, v85
    v_exp_f32 v86, v86
    v_mfma_f32_32x32x16_bf16 v[96:111], v[20:23], v[16:19], v[64:79]
    ds_read_b128 v[20:23], v120 offset:12288
    v_exp_f32 v87, v87
    v_exp_f32 v88, v88
    v_exp_f32 v89, v89
    v_exp_f32 v90, v90
    v_exp_f32 v91, v91
    v_smfmac_f32_32x32x32_bf16 v[48:63], v[36:39], v[80:87], v122
    s_mov_b64 exec, s[70:71]
    ds_read_b128 v[36:39], v121 offset:10240
    ds_read_b128 v[44:47], v121 offset:11264
    s_mov_b64 exec, -1
    s_add_u32 m0, s83, 16384
    s_add_u32 s72, s82, 73728
    buffer_load_dwordx4 v3, s[44:47], s72 offen sc1 lds
    v_exp_f32 v92, v92
    v_exp_f32 v93, v93
    v_exp_f32 v94, v94
    v_exp_f32 v95, v95
    v_exp_f32 v96, v96
    v_exp_f32 v97, v97
    v_exp_f32 v98, v98
    v_smfmac_f32_32x32x32_bf16 v[48:63], v[40:43], v[88:95], v122
    s_setprio 2
    s_waitcnt lgkmcnt(0)
    v_exp_f32 v99, v99
    v_exp_f32 v100, v100
    v_exp_f32 v101, v101
    v_exp_f32 v102, v102
    v_mfma_f32_32x32x16_bf16 v[80:95], v[20:23], v[16:19], v[64:79]
    ds_read_b128 v[20:23], v120 offset:14336
    v_exp_f32 v103, v103
    v_exp_f32 v104, v104
    v_exp_f32 v105, v105
    v_exp_f32 v106, v106
    v_exp_f32 v107, v107
    v_smfmac_f32_32x32x32_bf16 v[48:63], v[36:39], v[96:103], v122
    s_mov_b64 exec, s[70:71]
    ds_read_b128 v[36:39], v121 offset:12288
    ds_read_b128 v[40:43], v121 offset:13312
    s_mov_b64 exec, -1
    v_exp_f32 v108, v108
    v_exp_f32 v109, v109
    v_exp_f32 v110, v110
    v_exp_f32 v111, v111
    buffer_store_dwordx4 v[148:151], v3, s[44:47], s65 offen offset:2048 sc1
    v_exp_f32 v80, v80
    v_exp_f32 v81, v81
    v_exp_f32 v82, v82
    v_smfmac_f32_32x32x32_bf16 v[48:63], v[44:47], v[104:111], v122
    s_setprio 1
    s_waitcnt lgkmcnt(0)
    v_exp_f32 v83, v83
    v_exp_f32 v84, v84
    v_exp_f32 v85, v85
    v_exp_f32 v86, v86
    v_mfma_f32_32x32x16_bf16 v[96:111], v[20:23], v[16:19], v[64:79]
    ds_read_b128 v[20:23], v120 offset:24576
    v_exp_f32 v87, v87
    v_exp_f32 v88, v88
    v_exp_f32 v89, v89
    v_exp_f32 v90, v90
    v_exp_f32 v91, v91
    v_smfmac_f32_32x32x32_bf16 v[48:63], v[36:39], v[80:87], v122
    s_mov_b64 exec, s[70:71]
    ds_read_b128 v[36:39], v121 offset:14336
    ds_read_b128 v[44:47], v121 offset:15360
    s_mov_b64 exec, -1
    v_exp_f32 v92, v92
    v_exp_f32 v93, v93
    v_exp_f32 v94, v94
    v_exp_f32 v95, v95
    v_exp_f32 v96, v96
    v_exp_f32 v97, v97
    v_exp_f32 v98, v98
    v_smfmac_f32_32x32x32_bf16 v[48:63], v[40:43], v[88:95], v122
    s_setprio 0
    s_waitcnt lgkmcnt(0)
    v_exp_f32 v99, v99
    v_exp_f32 v100, v100
    v_exp_f32 v101, v101
    v_exp_f32 v102, v102
    v_mfma_f32_32x32x16_bf16 v[80:95], v[20:23], v[16:19], v[64:79]
    ds_read_b128 v[20:23], v120 offset:26624
    v_exp_f32 v103, v103
    v_exp_f32 v104, v104
    v_exp_f32 v105, v105
    v_exp_f32 v106, v106
    v_exp_f32 v107, v107
    v_smfmac_f32_32x32x32_bf16 v[48:63], v[36:39], v[96:103], v122
    s_mov_b64 exec, s[70:71]
    ds_read_b128 v[36:39], v121 offset:24576
    ds_read_b128 v[40:43], v121 offset:25600
    s_mov_b64 exec, -1
    v_exp_f32 v108, v108
    v_exp_f32 v109, v109
    v_exp_f32 v110, v110
    v_exp_f32 v111, v111
    buffer_store_dwordx4 v[152:155], v3, s[44:47], s65 offen offset:3072 sc1
    v_exp_f32 v80, v80
    v_exp_f32 v81, v81
    v_exp_f32 v82, v82
    v_smfmac_f32_32x32x32_bf16 v[48:63], v[44:47], v[104:111], v122
    s_waitcnt vmcnt(5) lgkmcnt(0)
    s_barrier
    s_setprio 3
    v_exp_f32 v83, v83
    v_exp_f32 v84, v84
    v_exp_f32 v85, v85
    v_exp_f32 v86, v86
    v_mfma_f32_32x32x16_bf16 v[96:111], v[20:23], v[16:19], v[64:79]
    ds_read_b128 v[20:23], v120 offset:28672
    v_exp_f32 v87, v87
    v_exp_f32 v88, v88
    v_exp_f32 v89, v89
    v_exp_f32 v90, v90
    v_exp_f32 v91, v91
    v_smfmac_f32_32x32x32_bf16 v[48:63], v[36:39], v[80:87], v122
    s_mov_b64 exec, s[70:71]
    ds_read_b128 v[36:39], v121 offset:26624
    ds_read_b128 v[44:47], v121 offset:27648
    s_mov_b64 exec, -1
    s_add_u32 m0, s83, 8192
    s_add_u32 s72, s82, 81920
    buffer_load_dwordx4 v3, s[44:47], s72 offen sc1 lds
    v_exp_f32 v92, v92
    v_exp_f32 v93, v93
    v_exp_f32 v94, v94
    v_exp_f32 v95, v95
    v_exp_f32 v96, v96
    v_exp_f32 v97, v97
    v_exp_f32 v98, v98
    v_smfmac_f32_32x32x32_bf16 v[48:63], v[40:43], v[88:95], v122
    s_setprio 2
    s_waitcnt lgkmcnt(0)
    v_exp_f32 v99, v99
    v_exp_f32 v100, v100
    v_exp_f32 v101, v101
    v_exp_f32 v102, v102
    v_mfma_f32_32x32x16_bf16 v[80:95], v[20:23], v[16:19], v[64:79]
    ds_read_b128 v[20:23], v120 offset:30720
    v_exp_f32 v103, v103
    v_exp_f32 v104, v104
    v_exp_f32 v105, v105
    v_exp_f32 v106, v106
    v_exp_f32 v107, v107
    v_smfmac_f32_32x32x32_bf16 v[48:63], v[36:39], v[96:103], v122
    s_mov_b64 exec, s[70:71]
    ds_read_b128 v[36:39], v121 offset:28672
    ds_read_b128 v[40:43], v121 offset:29696
    s_mov_b64 exec, -1
    s_add_u32 m0, s81, 0
    s_add_u32 s72, s14, 0
    buffer_load_dwordx4 v123, s[48:51], s72 offen lds
    v_exp_f32 v108, v108
    v_exp_f32 v109, v109
    v_exp_f32 v110, v110
    v_exp_f32 v111, v111
    v_exp_f32 v80, v80
    v_exp_f32 v81, v81
    v_exp_f32 v82, v82
    v_smfmac_f32_32x32x32_bf16 v[48:63], v[44:47], v[104:111], v122
    s_setprio 1
    s_waitcnt lgkmcnt(0)
    v_exp_f32 v83, v83
    v_exp_f32 v84, v84
    v_exp_f32 v85, v85
    v_exp_f32 v86, v86
    v_mfma_f32_32x32x16_bf16 v[96:111], v[20:23], v[16:19], v[64:79]
    ds_read_b128 v[20:23], v120 offset:0
    v_exp_f32 v87, v87
    v_exp_f32 v88, v88
    v_exp_f32 v89, v89
    v_exp_f32 v90, v90
    v_exp_f32 v91, v91
    v_smfmac_f32_32x32x32_bf16 v[48:63], v[36:39], v[80:87], v122
    s_mov_b64 exec, s[70:71]
    ds_read_b128 v[36:39], v121 offset:30720
    ds_read_b128 v[44:47], v121 offset:31744
    s_mov_b64 exec, -1
    s_add_u32 m0, s81, 8192
    s_add_u32 s72, s14, 16384
    buffer_load_dwordx4 v123, s[48:51], s72 offen lds
    v_exp_f32 v92, v92
    v_exp_f32 v93, v93
    v_exp_f32 v94, v94
    v_exp_f32 v95, v95
    v_exp_f32 v96, v96
    v_exp_f32 v97, v97
    v_exp_f32 v98, v98
    v_smfmac_f32_32x32x32_bf16 v[48:63], v[40:43], v[88:95], v122
    s_setprio 0
    s_waitcnt lgkmcnt(0)
    v_exp_f32 v99, v99
    v_exp_f32 v100, v100
    v_exp_f32 v101, v101
    v_exp_f32 v102, v102
    v_mfma_f32_32x32x16_bf16 v[80:95], v[20:23], v[16:19], v[64:79]
    ds_read_b128 v[20:23], v120 offset:2048
    v_exp_f32 v103, v103
    v_exp_f32 v104, v104
    v_exp_f32 v105, v105
    v_exp_f32 v106, v106
    v_exp_f32 v107, v107
    v_smfmac_f32_32x32x32_bf16 v[48:63], v[36:39], v[96:103], v122
    s_mov_b64 exec, s[70:71]
    ds_read_b128 v[36:39], v121 offset:0
    ds_read_b128 v[40:43], v121 offset:1024
    s_mov_b64 exec, -1
    s_add_u32 m0, s81, 16384
    s_add_u32 s72, s14, 32768
    buffer_load_dwordx4 v123, s[48:51], s72 offen lds
    v_exp_f32 v108, v108
    v_exp_f32 v109, v109
    v_exp_f32 v110, v110
    v_exp_f32 v111, v111
    v_exp_f32 v80, v80
    v_exp_f32 v81, v81
    v_exp_f32 v82, v82
    v_smfmac_f32_32x32x32_bf16 v[48:63], v[44:47], v[104:111], v122
    s_waitcnt vmcnt(6) lgkmcnt(0)
    s_barrier
    s_setprio 3
    v_exp_f32 v83, v83
    v_exp_f32 v84, v84
    v_exp_f32 v85, v85
    v_exp_f32 v86, v86
    v_mfma_f32_32x32x16_bf16 v[96:111], v[20:23], v[16:19], v[64:79]
    ds_read_b128 v[20:23], v120 offset:4096
    v_exp_f32 v87, v87
    v_exp_f32 v88, v88
    v_exp_f32 v89, v89
    v_exp_f32 v90, v90
    v_exp_f32 v91, v91
    v_smfmac_f32_32x32x32_bf16 v[48:63], v[36:39], v[80:87], v122
    s_mov_b64 exec, s[70:71]
    ds_read_b128 v[36:39], v121 offset:2048
    ds_read_b128 v[44:47], v121 offset:3072
    s_mov_b64 exec, -1
    s_add_u32 m0, s83, 24576
    s_add_u32 s72, s82, 90112
    buffer_load_dwordx4 v3, s[44:47], s72 offen sc1 lds
    v_exp_f32 v92, v92
    v_exp_f32 v93, v93
    s_add_u32 m0, s81, 24576
    s_add_u32 s72, s14, 49152
    buffer_load_dwordx4 v123, s[48:51], s72 offen lds
    v_exp_f32 v94, v94
    v_exp_f32 v95, v95
    v_exp_f32 v96, v96
    v_exp_f32 v97, v97
    v_exp_f32 v98, v98
    v_smfmac_f32_32x32x32_bf16 v[48:63], v[40:43], v[88:95], v122
    s_setprio 2
    s_waitcnt lgkmcnt(0)
    v_exp_f32 v99, v99
    v_exp_f32 v100, v100
    v_exp_f32 v101, v101
    v_exp_f32 v102, v102
    v_mfma_f32_32x32x16_bf16 v[80:95], v[20:23], v[16:19], v[64:79]
    ds_read_b128 v[20:23], v120 offset:6144
    v_exp_f32 v103, v103
    v_exp_f32 v104, v104
    v_exp_f32 v105, v105
    v_exp_f32 v106, v106
    v_exp_f32 v107, v107
    v_smfmac_f32_32x32x32_bf16 v[48:63], v[36:39], v[96:103], v122
    s_mov_b64 exec, s[70:71]
    ds_read_b128 v[36:39], v121 offset:4096
    ds_read_b128 v[40:43], v121 offset:5120
    s_mov_b64 exec, -1
    s_add_u32 m0, s81, 32768
    s_add_u32 s72, s14, 65536
    buffer_load_dwordx4 v123, s[48:51], s72 offen lds
    v_exp_f32 v108, v108
    v_exp_f32 v109, v109
    v_exp_f32 v110, v110
    v_exp_f32 v111, v111
    v_exp_f32 v80, v80
    v_exp_f32 v81, v81
    v_exp_f32 v82, v82
    v_smfmac_f32_32x32x32_bf16 v[48:63], v[44:47], v[104:111], v122
    s_setprio 1
    s_waitcnt lgkmcnt(0)
    v_exp_f32 v83, v83
    v_exp_f32 v84, v84
    v_exp_f32 v85, v85
    v_exp_f32 v86, v86
    v_mfma_f32_32x32x16_bf16 v[96:111], v[20:23], v[16:19], v[64:79]
    ds_read_b128 v[20:23], v120 offset:16384
    v_exp_f32 v87, v87
    v_exp_f32 v88, v88
    v_exp_f32 v89, v89
    v_exp_f32 v90, v90
    v_exp_f32 v91, v91
    v_smfmac_f32_32x32x32_bf16 v[48:63], v[36:39], v[80:87], v122
    s_mov_b64 exec, s[70:71]
    ds_read_b128 v[36:39], v121 offset:6144
    ds_read_b128 v[44:47], v121 offset:7168
    s_mov_b64 exec, -1
    s_add_u32 m0, s81, 40960
    s_add_u32 s72, s14, 81920
    buffer_load_dwordx4 v123, s[48:51], s72 offen lds
    v_exp_f32 v92, v92
    v_exp_f32 v93, v93
    v_exp_f32 v94, v94
    v_exp_f32 v95, v95
    v_exp_f32 v96, v96
    v_exp_f32 v97, v97
    v_exp_f32 v98, v98
    v_smfmac_f32_32x32x32_bf16 v[48:63], v[40:43], v[88:95], v122
    s_setprio 0
    s_waitcnt lgkmcnt(0)
    v_exp_f32 v99, v99
    v_exp_f32 v100, v100
    v_exp_f32 v101, v101
    v_exp_f32 v102, v102
    v_mfma_f32_32x32x16_bf16 v[80:95], v[20:23], v[16:19], v[64:79]
    ds_read_b128 v[20:23], v120 offset:18432
    v_exp_f32 v103, v103
    v_exp_f32 v104, v104
    v_exp_f32 v105, v105
    v_exp_f32 v106, v106
    v_exp_f32 v107, v107
    v_smfmac_f32_32x32x32_bf16 v[48:63], v[36:39], v[96:103], v122
    s_mov_b64 exec, s[70:71]
    ds_read_b128 v[36:39], v121 offset:16384
    ds_read_b128 v[40:43], v121 offset:17408
    s_mov_b64 exec, -1
    s_add_u32 m0, s81, 49152
    s_add_u32 s72, s14, 98304
    buffer_load_dwordx4 v123, s[48:51], s72 offen lds
    v_exp_f32 v108, v108
    v_exp_f32 v109, v109
    v_exp_f32 v110, v110
    v_exp_f32 v111, v111
    v_exp_f32 v80, v80
    v_exp_f32 v81, v81
    v_exp_f32 v82, v82
    v_smfmac_f32_32x32x32_bf16 v[48:63], v[44:47], v[104:111], v122
    s_waitcnt vmcnt(8) lgkmcnt(0)
    s_barrier
    s_cmp_lg_u32 s28, 0
    s_cbranch_scc1 HF_41
    s_lshl3_add_u32 s72, s26, s27
    s_lshl_b32 s72, s72, 4
    s_add_u32 s72, s72, 8192
    v_mov_b32 v31, s29
    s_mov_b64 exec, 1
    buffer_store_dword v31, off, s[44:47], s72 sc1
    s_mov_b64 exec, -1
HF_41:
    s_setprio 3
    v_exp_f32 v83, v83
    v_exp_f32 v84, v84
    v_exp_f32 v85, v85
    v_exp_f32 v86, v86
    v_mfma_f32_32x32x16_bf16 v[96:111], v[20:23], v[16:19], v[64:79]
    ds_read_b128 v[20:23], v120 offset:20480
    v_exp_f32 v87, v87
    v_exp_f32 v88, v88
    v_exp_f32 v89, v89
    v_exp_f32 v90, v90
    v_exp_f32 v91, v91
    v_smfmac_f32_32x32x32_bf16 v[48:63], v[36:39], v[80:87], v122
    s_mov_b64 exec, s[70:71]
    ds_read_b128 v[36:39], v121 offset:18432
    ds_read_b128 v[44:47], v121 offset:19456
    s_mov_b64 exec, -1
    s_add_u32 m0, s83, 0
    s_add_u32 s72, s82, 98304
    buffer_load_dwordx4 v3, s[44:47], s72 offen sc1 lds
    v_exp_f32 v92, v92
    v_exp_f32 v93, v93
    s_add_u32 m0, s81, 57344
    s_add_u32 s72, s14, 114688
    buffer_load_dwordx4 v123, s[48:51], s72 offen lds
    v_exp_f32 v94, v94
    v_exp_f32 v95, v95
    v_exp_f32 v96, v96
    v_exp_f32 v97, v97
    v_exp_f32 v98, v98
    v_smfmac_f32_32x32x32_bf16 v[48:63], v[40:43], v[88:95], v122
    s_setprio 2
    s_waitcnt lgkmcnt(0)
    v_exp_f32 v99, v99
    v_exp_f32 v100, v100
    v_exp_f32 v101, v101
    v_exp_f32 v102, v102
    v_mfma_f32_32x32x16_bf16 v[80:95], v[20:23], v[16:19], v[64:79]
    ds_read_b128 v[20:23], v120 offset:22528
    v_exp_f32 v103, v103
    v_exp_f32 v104, v104
    v_exp_f32 v105, v105
    v_exp_f32 v106, v106
    v_exp_f32 v107, v107
    v_smfmac_f32_32x32x32_bf16 v[48:63], v[36:39], v[96:103], v122
    s_mov_b64 exec, s[70:71]
    ds_read_b128 v[36:39], v121 offset:20480
    ds_read_b128 v[40:43], v121 offset:21504
    s_mov_b64 exec, -1
    s_add_u32 m0, s81, 99328
    s_add_u32 s72, s14, 131072
    buffer_load_dwordx4 v123, s[48:51], s72 offen lds
    v_exp_f32 v108, v108
    v_exp_f32 v109, v109
    v_exp_f32 v110, v110
    v_exp_f32 v111, v111
    v_exp_f32 v80, v80
    v_exp_f32 v81, v81
    v_exp_f32 v82, v82
    v_smfmac_f32_32x32x32_bf16 v[48:63], v[44:47], v[104:111], v122
    s_setprio 1
    s_waitcnt lgkmcnt(0)
    v_exp_f32 v83, v83
    v_exp_f32 v84, v84
    v_exp_f32 v85, v85
    v_exp_f32 v86, v86
    v_mfma_f32_32x32x16_bf16 v[96:111], v[20:23], v[16:19], v[64:79]
    ds_read_b128 v[20:23], v120 offset:8192
    v_exp_f32 v87, v87
    v_exp_f32 v88, v88
    v_exp_f32 v89, v89
    v_exp_f32 v90, v90
    v_exp_f32 v91, v91
    v_smfmac_f32_32x32x32_bf16 v[48:63], v[36:39], v[80:87], v122
    s_mov_b64 exec, s[70:71]
    ds_read_b128 v[36:39], v121 offset:22528
    ds_read_b128 v[44:47], v121 offset:23552
    s_mov_b64 exec, -1
    s_add_u32 m0, s81, 107520
    s_add_u32 s72, s14, 147456
    buffer_load_dwordx4 v123, s[48:51], s72 offen lds
    v_exp_f32 v92, v92
    v_exp_f32 v93, v93
    v_exp_f32 v94, v94
    v_exp_f32 v95, v95
    v_exp_f32 v96, v96
    v_exp_f32 v97, v97
    v_exp_f32 v98, v98
    v_smfmac_f32_32x32x32_bf16 v[48:63], v[40:43], v[88:95], v122
    s_setprio 0
    s_waitcnt lgkmcnt(0)
    v_exp_f32 v99, v99
    v_exp_f32 v100, v100
    v_exp_f32 v101, v101
    v_exp_f32 v102, v102
    v_mfma_f32_32x32x16_bf16 v[80:95], v[20:23], v[16:19], v[64:79]
    ds_read_b128 v[20:23], v120 offset:10240
    v_exp_f32 v103, v103
    v_exp_f32 v104, v104
    v_exp_f32 v105, v105
    v_exp_f32 v106, v106
    v_exp_f32 v107, v107
    v_smfmac_f32_32x32x32_bf16 v[48:63], v[36:39], v[96:103], v122
    s_mov_b64 exec, s[70:71]
    ds_read_b128 v[36:39], v121 offset:8192
    ds_read_b128 v[40:43], v121 offset:9216
    s_mov_b64 exec, -1
    s_add_u32 m0, s81, 115712
    s_add_u32 s72, s14, 163840
    buffer_load_dwordx4 v123, s[48:51], s72 offen lds
    v_exp_f32 v108, v108
    v_exp_f32 v109, v109
    v_exp_f32 v110, v110
    v_exp_f32 v111, v111
    v_exp_f32 v80, v80
    v_exp_f32 v81, v81
    v_exp_f32 v82, v82
    v_smfmac_f32_32x32x32_bf16 v[48:63], v[44:47], v[104:111], v122
    s_waitcnt vmcnt(9) lgkmcnt(0)
    s_barrier
    s_setprio 3
    v_exp_f32 v83, v83
    v_exp_f32 v84, v84
    v_exp_f32 v85, v85
    v_exp_f32 v86, v86
    v_mfma_f32_32x32x16_bf16 v[96:111], v[20:23], v[16:19], v[64:79]
    ds_read_b128 v[20:23], v120 offset:12288
    v_exp_f32 v87, v87
    v_exp_f32 v88, v88
    v_exp_f32 v89, v89
    v_exp_f32 v90, v90
    v_exp_f32 v91, v91
    v_smfmac_f32_32x32x32_bf16 v[48:63], v[36:39], v[80:87], v122
    s_mov_b64 exec, s[70:71]
    ds_read_b128 v[36:39], v121 offset:10240
    ds_read_b128 v[44:47], v121 offset:11264
    s_mov_b64 exec, -1
    s_add_u32 m0, s83, 16384
    s_add_u32 s72, s82, 106496
    buffer_load_dwordx4 v3, s[44:47], s72 offen sc1 lds
    v_exp_f32 v92, v92
    v_exp_f32 v93, v93
    s_lshl2_add_u32 s73, s26, s31
    s_lshl_b32 s73, s73, 5
    s_add_u32 s73, s73, 8192
    v_and_b32 v30, 16, v3
    buffer_load_dword v29, v30, s[44:47], s73 offen sc1
    v_exp_f32 v94, v94
    v_exp_f32 v95, v95
    v_exp_f32 v96, v96
    v_exp_f32 v97, v97
    v_exp_f32 v98, v98
    v_smfmac_f32_32x32x32_bf16 v[48:63], v[40:43], v[88:95], v122
    s_setprio 2
    s_waitcnt lgkmcnt(0)
    v_exp_f32 v99, v99
    v_exp_f32 v100, v100
    v_exp_f32 v101, v101
    v_exp_f32 v102, v102
    v_mfma_f32_32x32x16_bf16 v[80:95], v[20:23], v[16:19], v[64:79]
    ds_read_b128 v[20:23], v120 offset:14336
    v_exp_f32 v103, v103
    v_exp_f32 v104, v104
    v_exp_f32 v105, v105
    v_exp_f32 v106, v106
    v_exp_f32 v107, v107
    v_smfmac_f32_32x32x32_bf16 v[48:63], v[36:39], v[96:103], v122
    s_mov_b64 exec, s[70:71]
    ds_read_b128 v[36:39], v121 offset:12288
    ds_read_b128 v[40:43], v121 offset:13312
    s_mov_b64 exec, -1
    s_add_u32 m0, s81, 123904
    s_add_u32 s72, s14, 180224
    buffer_load_dwordx4 v123, s[48:51], s72 offen lds
    v_exp_f32 v108, v108
    v_exp_f32 v109, v109
    v_exp_f32 v110, v110
    v_exp_f32 v111, v111
    v_exp_f32 v80, v80
    v_exp_f32 v81, v81
    v_exp_f32 v82, v82
    v_smfmac_f32_32x32x32_bf16 v[48:63], v[44:47], v[104:111], v122
    s_setprio 1
    s_waitcnt lgkmcnt(0)
    v_exp_f32 v83, v83
    v_exp_f32 v84, v84
    v_exp_f32 v85, v85
    v_exp_f32 v86, v86
    v_mfma_f32_32x32x16_bf16 v[96:111], v[20:23], v[16:19], v[64:79]
    ds_read_b128 v[20:23], v120 offset:24576
    v_exp_f32 v87, v87
    v_exp_f32 v88, v88
    v_exp_f32 v89, v89
    v_exp_f32 v90, v90
    v_exp_f32 v91, v91
    v_smfmac_f32_32x32x32_bf16 v[48:63], v[36:39], v[80:87], v122
    s_mov_b64 exec, s[70:71]
    ds_read_b128 v[36:39], v121 offset:14336
    ds_read_b128 v[44:47], v121 offset:15360
    s_mov_b64 exec, -1
    s_add_u32 m0, s81, 132096
    s_add_u32 s72, s14, 196608
    buffer_load_dwordx4 v123, s[48:51], s72 offen lds
    v_exp_f32 v92, v92
    v_exp_f32 v93, v93
    v_exp_f32 v94, v94
    v_exp_f32 v95, v95
    v_exp_f32 v96, v96
    v_exp_f32 v97, v97
    v_exp_f32 v98, v98
    v_smfmac_f32_32x32x32_bf16 v[48:63], v[40:43], v[88:95], v122
    s_setprio 0
    s_waitcnt lgkmcnt(0)
    v_exp_f32 v99, v99
    v_exp_f32 v100, v100
    v_exp_f32 v101, v101
    v_exp_f32 v102, v102
    v_mfma_f32_32x32x16_bf16 v[80:95], v[20:23], v[16:19], v[64:79]
    ds_read_b128 v[20:23], v120 offset:26624
    v_exp_f32 v103, v103
    v_exp_f32 v104, v104
    v_exp_f32 v105, v105
    v_exp_f32 v106, v106
    v_exp_f32 v107, v107
    v_smfmac_f32_32x32x32_bf16 v[48:63], v[36:39], v[96:103], v122
    s_mov_b64 exec, s[70:71]
    ds_read_b128 v[36:39], v121 offset:24576
    ds_read_b128 v[40:43], v121 offset:25600
    s_mov_b64 exec, -1
    s_add_u32 m0, s81, 140288
    s_add_u32 s72, s14, 212992
    buffer_load_dwordx4 v123, s[48:51], s72 offen lds
    v_exp_f32 v108, v108
    v_exp_f32 v109, v109
    v_exp_f32 v110, v110
    v_exp_f32 v111, v111
    v_exp_f32 v80, v80
    v_exp_f32 v81, v81
    v_exp_f32 v82, v82
    v_smfmac_f32_32x32x32_bf16 v[48:63], v[44:47], v[104:111], v122
    s_waitcnt vmcnt(9) lgkmcnt(0)
    s_barrier
    s_setprio 3
    v_exp_f32 v83, v83
    v_exp_f32 v84, v84
    v_exp_f32 v85, v85
    v_exp_f32 v86, v86
    v_mfma_f32_32x32x16_bf16 v[96:111], v[20:23], v[16:19], v[64:79]
    ds_read_b128 v[20:23], v120 offset:28672
    v_exp_f32 v87, v87
    v_exp_f32 v88, v88
    v_exp_f32 v89, v89
    v_exp_f32 v90, v90
    v_exp_f32 v91, v91
    v_smfmac_f32_32x32x32_bf16 v[48:63], v[36:39], v[80:87], v122
    s_mov_b64 exec, s[70:71]
    ds_read_b128 v[36:39], v121 offset:26624
    ds_read_b128 v[44:47], v121 offset:27648
    s_mov_b64 exec, -1
    s_add_u32 m0, s83, 8192
    s_add_u32 s72, s82, 114688
    buffer_load_dwordx4 v3, s[44:47], s72 offen sc1 lds
    s_waitcnt vmcnt(4)
    s_mov_b32 s80, 0
PL_43:
    v_xor_b32 v29, s29, v29
    v_cmp_ne_u32 vcc, 0, v29
    s_nop 4
    s_cbranch_vccz PD_42
    s_add_u32 s80, s80, 1
    s_cmp_gt_u32 s80, 200000
    s_cbranch_scc1 PD_42
    s_sleep 8
    buffer_load_dword v29, v30, s[44:47], s73 offen sc1
    s_waitcnt vmcnt(0)
    s_branch PL_43
PD_42:
    v_exp_f32 v92, v92
    v_exp_f32 v93, v93
    s_add_u32 m0, s81, 148480
    s_add_u32 s72, s14, 229376
    buffer_load_dwordx4 v123, s[48:51], s72 offen lds
    v_exp_f32 v94, v94
    v_exp_f32 v95, v95
    v_exp_f32 v96, v96
    v_exp_f32 v97, v97
    v_exp_f32 v98, v98
    v_smfmac_f32_32x32x32_bf16 v[48:63], v[40:43], v[88:95], v122
    s_setprio 2
    s_waitcnt lgkmcnt(0)
    buffer_load_dwordx4 v[164:167], v3, s[44:47], s78 offen offset:0 sc1
    v_exp_f32 v99, v99
    v_exp_f32 v100, v100
    v_exp_f32 v101, v101
    v_exp_f32 v102, v102
    v_mfma_f32_32x32x16_bf16 v[80:95], v[20:23], v[16:19], v[64:79]
    ds_read_b128 v[20:23], v120 offset:30720
    v_exp_f32 v103, v103
    v_exp_f32 v104, v104
    v_exp_f32 v105, v105
    v_exp_f32 v106, v106
    v_exp_f32 v107, v107
    v_smfmac_f32_32x32x32_bf16 v[48:63], v[36:39], v[96:103], v122
    s_mov_b64 exec, s[70:71]
    ds_read_b128 v[36:39], v121 offset:28672
    ds_read_b128 v[40:43], v121 offset:29696
    s_mov_b64 exec, -1
    v_exp_f32 v108, v108
    v_exp_f32 v109, v109
    v_exp_f32 v110, v110
    buffer_load_dwordx4 v[168:171], v3, s[44:47], s78 offen offset:1024 sc1
    v_exp_f32 v111, v111
    v_exp_f32 v80, v80
    v_exp_f32 v81, v81
    v_exp_f32 v82, v82
    v_smfmac_f32_32x32x32_bf16 v[48:63], v[44:47], v[104:111], v122
    s_setprio 1
    s_waitcnt lgkmcnt(0)
    buffer_load_dwordx4 v[172:175], v3, s[44:47], s78 offen offset:2048 sc1
    v_exp_f32 v83, v83
    v_exp_f32 v84, v84
    v_exp_f32 v85, v85
    v_exp_f32 v86, v86
    v_mfma_f32_32x32x16_bf16 v[96:111], v[20:23], v[16:19], v[64:79]
    ds_read_b128 v[20:23], v120 offset:0
    v_exp_f32 v87, v87
    v_exp_f32 v88, v88
    v_exp_f32 v89, v89
    v_exp_f32 v90, v90
    v_exp_f32 v91, v91
    v_smfmac_f32_32x32x32_bf16 v[48:63], v[36:39], v[80:87], v122
    s_mov_b64 exec, s[70:71]
    ds_read_b128 v[36:39], v121 offset:30720
    ds_read_b128 v[44:47], v121 offset:31744
    s_mov_b64 exec, -1
    v_exp_f32 v92, v92
    v_exp_f32 v93, v93
    v_exp_f32 v94, v94
    buffer_load_dwordx4 v[176:179], v3, s[44:47], s78 offen offset:3072 sc1
    v_exp_f32 v95, v95
    v_exp_f32 v96, v96
    v_exp_f32 v97, v97
    v_exp_f32 v98, v98
    v_smfmac_f32_32x32x32_bf16 v[48:63], v[40:43], v[88:95], v122
    s_setprio 0
    s_waitcnt lgkmcnt(0)
    s_add_u32 s78, s78, 4096
    buffer_load_dwordx4 v[180:183], v3, s[44:47], s78 offen offset:0 sc1
    v_exp_f32 v99, v99
    v_exp_f32 v100, v100
    v_exp_f32 v101, v101
    v_exp_f32 v102, v102
    v_mfma_f32_32x32x16_bf16 v[80:95], v[20:23], v[16:19], v[64:79]
    ds_read_b128 v[20:23], v120 offset:2048
    v_exp_f32 v103, v103
    v_exp_f32 v104, v104
    v_exp_f32 v105, v105
    v_exp_f32 v106, v106
    v_exp_f32 v107, v107
    v_smfmac_f32_32x32x32_bf16 v[48:63], v[36:39], v[96:103], v122
    s_mov_b64 exec, s[70:71]
    ds_read_b128 v[36:39], v121 offset:0
    ds_read_b128 v[40:43], v121 offset:1024
    s_mov_b64 exec, -1
    v_exp_f32 v108, v108
    v_exp_f32 v109, v109
    ds_read_b64_tr_b16 v[112:113], v124 offset:0
    ds_read_b64_tr_b16 v[114:115], v124 offset:512
    v_exp_f32 v110, v110
    ds_read_b64_tr_b16 v[116:117], v124 offset:1024
    ds_read_b64_tr_b16 v[118:119], v124 offset:1536
    buffer_load_dwordx4 v[184:187], v3, s[44:47], s78 offen offset:1024 sc1
    v_exp_f32 v111, v111
    v_exp_f32 v80, v80
    v_exp_f32 v81, v81
    v_exp_f32 v82, v82
    v_smfmac_f32_32x32x32_bf16 v[48:63], v[44:47], v[104:111], v122
    s_waitcnt lgkmcnt(0)
    s_barrier
    s_setprio 3
    buffer_load_dwordx4 v[188:191], v3, s[44:47], s78 offen offset:2048 sc1
    v_exp_f32 v83, v83
    v_exp_f32 v84, v84
    v_exp_f32 v85, v85
    v_exp_f32 v86, v86
    v_mfma_f32_32x32x16_bf16 v[96:111], v[20:23], v[16:19], v[64:79]
    ds_read_b128 v[20:23], v120 offset:4096
    v_exp_f32 v87, v87
    v_exp_f32 v88, v88
    v_exp_f32 v89, v89
    v_exp_f32 v90, v90
    v_exp_f32 v91, v91
    v_smfmac_f32_32x32x32_bf16 v[48:63], v[36:39], v[80:87], v122
    s_mov_b64 exec, s[70:71]
    ds_read_b128 v[36:39], v121 offset:2048
    ds_read_b128 v[44:47], v121 offset:3072
    s_mov_b64 exec, -1
    s_add_u32 m0, s83, 24576
    s_add_u32 s72, s82, 122880
    buffer_load_dwordx4 v3, s[44:47], s72 offen sc1 lds
    v_exp_f32 v92, v92
    v_exp_f32 v93, v93
    s_waitcnt vmcnt(7)
    v_mfma_f32_32x32x16_bf16 v[132:147], v[112:115], v[164:167], 0
    ds_read_b64_tr_b16 v[112:113], v124 offset:8192
    ds_read_b64_tr_b16 v[114:115], v124 offset:8704
    s_add_u32 m0, s81, 0
    s_add_u32 s72, s14, 245760
    buffer_load_dwordx4 v123, s[48:51], s72 offen lds
    v_exp_f32 v94, v94
    v_mfma_f32_32x32x16_bf16 v[148:163], v[116:119], v[164:167], 0
    ds_read_b64_tr_b16 v[116:117], v124 offset:9216
    ds_read_b64_tr_b16 v[118:119], v124 offset:9728
    buffer_load_dwordx4 v[192:195], v3, s[44:47], s78 offen offset:3072 sc1
    v_exp_f32 v95, v95
    v_exp_f32 v96, v96
    v_exp_f32 v97, v97
    v_exp_f32 v98, v98
    v_smfmac_f32_32x32x32_bf16 v[48:63], v[40:43], v[88:95], v122
    s_setprio 2
    s_waitcnt lgkmcnt(0)
    s_add_u32 s78, s78, 4096
    buffer_load_dwordx4 v[196:199], v3, s[44:47], s78 offen offset:0 sc1
    v_exp_f32 v99, v99
    v_exp_f32 v100, v100
    v_exp_f32 v101, v101
    v_exp_f32 v102, v102
    v_mfma_f32_32x32x16_bf16 v[80:95], v[20:23], v[16:19], v[64:79]
    ds_read_b128 v[20:23], v120 offset:6144
    v_exp_f32 v103, v103
    v_exp_f32 v104, v104
    v_exp_f32 v105, v105
    v_exp_f32 v106, v106
    v_exp_f32 v107, v107
    v_smfmac_f32_32x32x32_bf16 v[48:63], v[36:39], v[96:103], v122
    s_mov_b64 exec, s[70:71]
    ds_read_b128 v[36:39], v121 offset:4096
    ds_read_b128 v[40:43], v121 offset:5120
    s_mov_b64 exec, -1
    v_exp_f32 v108, v108
    v_exp_f32 v109, v109
    s_waitcnt vmcnt(9)
    v_mfma_f32_32x32x16_bf16 v[132:147], v[112:115], v[168:171], v[132:147]
    ds_read_b64_tr_b16 v[112:113], v124 offset:16384
    ds_read_b64_tr_b16 v[114:115], v124 offset:16896
    v_exp_f32 v110, v110
    v_mfma_f32_32x32x16_bf16 v[148:163], v[116:119], v[168:171], v[148:163]
    ds_read_b64_tr_b16 v[116:117], v124 offset:17408
    ds_read_b64_tr_b16 v[118:119], v124 offset:17920
    buffer_load_dwordx4 v[200:203], v3, s[44:47], s78 offen offset:1024 sc1
    v_exp_f32 v111, v111
    v_exp_f32 v80, v80
    v_exp_f32 v81, v81
    v_exp_f32 v82, v82
    v_smfmac_f32_32x32x32_bf16 v[48:63], v[44:47], v[104:111], v122
    s_setprio 1
    s_waitcnt lgkmcnt(0)
    buffer_load_dwordx4 v[204:207], v3, s[44:47], s78 offen offset:2048 sc1
    v_exp_f32 v83, v83
    v_exp_f32 v84, v84
    v_exp_f32 v85, v85
    v_exp_f32 v86, v86
    v_mfma_f32_32x32x16_bf16 v[96:111], v[20:23], v[16:19], v[64:79]
    ds_read_b128 v[20:23], v120 offset:16384
    v_exp_f32 v87, v87
    v_exp_f32 v88, v88
    v_exp_f32 v89, v89
    v_exp_f32 v90, v90
    v_exp_f32 v91, v91
    v_smfmac_f32_32x32x32_bf16 v[48:63], v[36:39], v[80:87], v122
    s_mov_b64 exec, s[70:71]
    ds_read_b128 v[36:39], v121 offset:6144
    ds_read_b128 v[44:47], v121 offset:7168
    s_mov_b64 exec, -1
    v_exp_f32 v92, v92
    v_exp_f32 v93, v93
    s_waitcnt vmcnt(10)
    v_mfma_f32_32x32x16_bf16 v[132:147], v[112:115], v[172:175], v[132:147]
    ds_read_b64_tr_b16 v[112:113], v124 offset:24576
    ds_read_b64_tr_b16 v[114:115], v124 offset:25088
    v_exp_f32 v94, v94
    v_mfma_f32_32x32x16_bf16 v[148:163], v[116:119], v[172:175], v[148:163]
    ds_read_b64_tr_b16 v[116:117], v124 offset:25600
    ds_read_b64_tr_b16 v[118:119], v124 offset:26112
    buffer_load_dwordx4 v[208:211], v3, s[44:47], s78 offen offset:3072 sc1
    v_exp_f32 v95, v95
    v_exp_f32 v96, v96
    v_exp_f32 v97, v97
    v_exp_f32 v98, v98
    v_smfmac_f32_32x32x32_bf16 v[48:63], v[40:43], v[88:95], v122
    s_setprio 0
    s_waitcnt lgkmcnt(0)
    s_add_u32 s78, s78, 4096
    buffer_load_dwordx4 v[212:215], v3, s[44:47], s78 offen offset:0 sc1
    v_exp_f32 v99, v99
    v_exp_f32 v100, v100
    v_exp_f32 v101, v101
    v_exp_f32 v102, v102
    v_mfma_f32_32x32x16_bf16 v[80:95], v[20:23], v[16:19], v[64:79]
    ds_read_b128 v[20:23], v120 offset:18432
    v_exp_f32 v103, v103
    v_exp_f32 v104, v104
    v_exp_f32 v105, v105
    v_exp_f32 v106, v106
    v_exp_f32 v107, v107
    v_smfmac_f32_32x32x32_bf16 v[48:63], v[36:39], v[96:103], v122
    s_mov_b64 exec, s[70:71]
    ds_read_b128 v[36:39], v121 offset:16384
    ds_read_b128 v[40:43], v121 offset:17408
    s_mov_b64 exec, -1
    v_exp_f32 v108, v108
    v_exp_f32 v109, v109
    s_waitcnt vmcnt(11)
    v_mfma_f32_32x32x16_bf16 v[132:147], v[112:115], v[176:179], v[132:147]
    ds_read_b64_tr_b16 v[112:113], v124 offset:32768
    ds_read_b64_tr_b16 v[114:115], v124 offset:33280
    v_exp_f32 v110, v110
    v_mfma_f32_32x32x16_bf16 v[148:163], v[116:119], v[176:179], v[148:163]
    ds_read_b64_tr_b16 v[116:117], v124 offset:33792
    ds_read_b64_tr_b16 v[118:119], v124 offset:34304
    buffer_load_dwordx4 v[216:219], v3, s[44:47], s78 offen offset:1024 sc1
    v_exp_f32 v111, v111
    v_exp_f32 v80, v80
    v_exp_f32 v81, v81
    v_exp_f32 v82, v82
    v_smfmac_f32_32x32x32_bf16 v[48:63], v[44:47], v[104:111], v122
    s_waitcnt lgkmcnt(0)
    s_barrier
    s_setprio 3
    buffer_load_dwordx4 v[220:223], v3, s[44:47], s78 offen offset:2048 sc1
    v_exp_f32 v83, v83
    v_exp_f32 v84, v84
    v_exp_f32 v85, v85
    v_exp_f32 v86, v86
    v_mfma_f32_32x32x16_bf16 v[96:111], v[20:23], v[16:19], v[64:79]
    ds_read_b128 v[20:23], v120 offset:20480
    v_exp_f32 v87, v87
    v_exp_f32 v88, v88
    v_exp_f32 v89, v89
    v_exp_f32 v90, v90
    v_exp_f32 v91, v91
    v_smfmac_f32_32x32x32_bf16 v[48:63], v[36:39], v[80:87], v122
    s_mov_b64 exec, s[70:71]
    ds_read_b128 v[36:39], v121 offset:18432
    ds_read_b128 v[44:47], v121 offset:19456
    s_mov_b64 exec, -1
    s_add_u32 m0, s81, 8192
    s_add_u32 s72, s14, 262144
    buffer_load_dwordx4 v123, s[48:51], s72 offen lds
    v_exp_f32 v92, v92
    v_exp_f32 v93, v93
    s_waitcnt vmcnt(13)
    v_mfma_f32_32x32x16_bf16 v[132:147], v[112:115], v[180:183], v[132:147]
    ds_read_b64_tr_b16 v[112:113], v124 offset:40960
    ds_read_b64_tr_b16 v[114:115], v124 offset:41472
    v_exp_f32 v94, v94
    v_mfma_f32_32x32x16_bf16 v[148:163], v[116:119], v[180:183], v[148:163]
    ds_read_b64_tr_b16 v[116:117], v124 offset:41984
    ds_read_b64_tr_b16 v[118:119], v124 offset:42496
    buffer_load_dwordx4 v[224:227], v3, s[44:47], s78 offen offset:3072 sc1
    v_exp_f32 v95, v95
    v_exp_f32 v96, v96
    v_exp_f32 v97, v97
    v_exp_f32 v98, v98
    v_smfmac_f32_32x32x32_bf16 v[48:63], v[40:43], v[88:95], v122
    s_setprio 2
    s_waitcnt lgkmcnt(0)
    s_add_u32 s78, s78, 4096
    buffer_load_dwordx4 v[228:231], v3, s[44:47], s78 offen offset:0 sc1
    v_exp_f32 v99, v99
    v_exp_f32 v100, v100
    v_exp_f32 v101, v101
    v_exp_f32 v102, v102
    v_mfma_f32_32x32x16_bf16 v[80:95], v[20:23], v[16:19], v[64:79]
    ds_read_b128 v[20:23], v120 offset:22528
    v_exp_f32 v103, v103
    v_exp_f32 v104, v104
    v_exp_f32 v105, v105
    v_exp_f32 v106, v106
    v_exp_f32 v107, v107
    v_smfmac_f32_32x32x32_bf16 v[48:63], v[36:39], v[96:103], v122
    s_mov_b64 exec, s[70:71]
    ds_read_b128 v[36:39], v121 offset:20480
    ds_read_b128 v[40:43], v121 offset:21504
    s_mov_b64 exec, -1
    s_add_u32 m0, s81, 16384
    s_add_u32 s72, s14, 278528
    buffer_load_dwordx4 v123, s[48:51], s72 offen lds
    v_exp_f32 v108, v108
    v_exp_f32 v109, v109
    s_waitcnt vmcnt(15)
    v_mfma_f32_32x32x16_bf16 v[132:147], v[112:115], v[184:187], v[132:147]
    ds_read_b64_tr_b16 v[112:113], v124 offset:49152
    ds_read_b64_tr_b16 v[114:115], v124 offset:49664
    v_exp_f32 v110, v110
    v_mfma_f32_32x32x16_bf16 v[148:163], v[116:119], v[184:187], v[148:163]
    ds_read_b64_tr_b16 v[116:117], v124 offset:50176
    ds_read_b64_tr_b16 v[118:119], v124 offset:50688
    buffer_load_dwordx4 v[232:235], v3, s[44:47], s78 offen offset:1024 sc1
    v_exp_f32 v111, v111
    v_exp_f32 v80, v80
    v_exp_f32 v81, v81
    v_exp_f32 v82, v82
    v_smfmac_f32_32x32x32_bf16 v[48:63], v[44:47], v[104:111], v122
    s_setprio 1
    s_waitcnt lgkmcnt(0)
    buffer_load_dwordx4 v[236:239], v3, s[44:47], s78 offen offset:2048 sc1
    v_exp_f32 v83, v83
    v_exp_f32 v84, v84
    v_exp_f32 v85, v85
    v_exp_f32 v86, v86
    v_mfma_f32_32x32x16_bf16 v[96:111], v[20:23], v[16:19], v[64:79]
    ds_read_b128 v[20:23], v120 offset:8192
    v_exp_f32 v87, v87
    v_exp_f32 v88, v88
    v_exp_f32 v89, v89
    v_exp_f32 v90, v90
    v_exp_f32 v91, v91
    v_smfmac_f32_32x32x32_bf16 v[48:63], v[36:39], v[80:87], v122
    s_mov_b64 exec, s[70:71]
    ds_read_b128 v[36:39], v121 offset:22528
    ds_read_b128 v[44:47], v121 offset:23552
    s_mov_b64 exec, -1
    s_add_u32 m0, s81, 24576
    s_add_u32 s72, s14, 294912
    buffer_load_dwordx4 v123, s[48:51], s72 offen lds
    v_exp_f32 v92, v92
    v_exp_f32 v93, v93
    s_waitcnt vmcnt(17)
    v_mfma_f32_32x32x16_bf16 v[132:147], v[112:115], v[188:191], v[132:147]
    ds_read_b64_tr_b16 v[112:113], v124 offset:57344
    ds_read_b64_tr_b16 v[114:115], v124 offset:57856
    v_exp_f32 v94, v94
    v_mfma_f32_32x32x16_bf16 v[148:163], v[116:119], v[188:191], v[148:163]
    ds_read_b64_tr_b16 v[116:117], v124 offset:58368
    ds_read_b64_tr_b16 v[118:119], v124 offset:58880
    buffer_load_dwordx4 v[240:243], v3, s[44:47], s78 offen offset:3072 sc1
    v_exp_f32 v95, v95
    v_exp_f32 v96, v96
    v_exp_f32 v97, v97
    v_exp_f32 v98, v98
    v_smfmac_f32_32x32x32_bf16 v[48:63], v[40:43], v[88:95], v122
    s_setprio 0
    s_waitcnt lgkmcnt(0)
    s_add_u32 s78, s78, 4096
    buffer_load_dwordx4 v[164:167], v3, s[44:47], s78 offen offset:0 sc1
    v_exp_f32 v99, v99
    v_exp_f32 v100, v100
    v_exp_f32 v101, v101
    v_exp_f32 v102, v102
    v_mfma_f32_32x32x16_bf16 v[80:95], v[20:23], v[16:19], v[64:79]
    ds_read_b128 v[20:23], v120 offset:10240
    v_exp_f32 v103, v103
    v_exp_f32 v104, v104
    v_exp_f32 v105, v105
    v_exp_f32 v106, v106
    v_exp_f32 v107, v107
    v_smfmac_f32_32x32x32_bf16 v[48:63], v[36:39], v[96:103], v122
    s_mov_b64 exec, s[70:71]
    ds_read_b128 v[36:39], v121 offset:8192
    ds_read_b128 v[40:43], v121 offset:9216
    s_mov_b64 exec, -1
    s_add_u32 m0, s81, 32768
    s_add_u32 s72, s14, 311296
    buffer_load_dwordx4 v123, s[48:51], s72 offen lds
    v_exp_f32 v108, v108
    v_exp_f32 v109, v109
    s_waitcnt vmcnt(17)
    v_mfma_f32_32x32x16_bf16 v[132:147], v[112:115], v[192:195], v[132:147]
    ds_read_b64_tr_b16 v[112:113], v126 offset:0
    ds_read_b64_tr_b16 v[114:115], v126 offset:512
    v_exp_f32 v110, v110
    v_mfma_f32_32x32x16_bf16 v[148:163], v[116:119], v[192:195], v[148:163]
    ds_read_b64_tr_b16 v[116:117], v126 offset:1024
    ds_read_b64_tr_b16 v[118:119], v126 offset:1536
    buffer_load_dwordx4 v[168:171], v3, s[44:47], s78 offen offset:1024 sc1
    v_exp_f32 v111, v111
    v_exp_f32 v80, v80
    v_exp_f32 v81, v81
    v_exp_f32 v82, v82
    v_smfmac_f32_32x32x32_bf16 v[48:63], v[44:47], v[104:111], v122
    s_waitcnt lgkmcnt(0)
    s_barrier
    s_setprio 3
    buffer_load_dwordx4 v[172:175], v3, s[44:47], s78 offen offset:2048 sc1
    v_exp_f32 v83, v83
    v_exp_f32 v84, v84
    v_exp_f32 v85, v85
    v_exp_f32 v86, v86
    v_mfma_f32_32x32x16_bf16 v[96:111], v[20:23], v[16:19], v[64:79]
    ds_read_b128 v[20:23], v120 offset:12288
    v_exp_f32 v87, v87
    v_exp_f32 v88, v88
    v_exp_f32 v89, v89
    v_exp_f32 v90, v90
    v_exp_f32 v91, v91
    v_smfmac_f32_32x32x32_bf16 v[48:63], v[36:39], v[80:87], v122
    s_mov_b64 exec, s[70:71]
    ds_read_b128 v[36:39], v121 offset:10240
    ds_read_b128 v[44:47], v121 offset:11264
    s_mov_b64 exec, -1
    s_add_u32 m0, s81, 40960
    s_add_u32 s72, s14, 327680
    buffer_load_dwordx4 v123, s[48:51], s72 offen lds
    v_exp_f32 v92, v92
    v_exp_f32 v93, v93
    s_waitcnt vmcnt(19)
    v_mfma_f32_32x32x16_bf16 v[132:147], v[112:115], v[196:199], v[132:147]
    ds_read_b64_tr_b16 v[112:113], v126 offset:8192
    ds_read_b64_tr_b16 v[114:115], v126 offset:8704
    v_exp_f32 v94, v94
    v_mfma_f32_32x32x16_bf16 v[148:163], v[116:119], v[196:199], v[148:163]
    ds_read_b64_tr_b16 v[116:117], v126 offset:9216
    ds_read_b64_tr_b16 v[118:119], v126 offset:9728
    buffer_load_dwordx4 v[176:179], v3, s[44:47], s78 offen offset:3072 sc1
    v_exp_f32 v95, v95
    v_exp_f32 v96, v96
    v_exp_f32 v97, v97
    v_exp_f32 v98, v98
    v_smfmac_f32_32x32x32_bf16 v[48:63], v[40:43], v[88:95], v122
    s_setprio 2
    s_waitcnt lgkmcnt(0)
    s_add_u32 s78, s78, 4096
    buffer_load_dwordx4 v[180:183], v3, s[44:47], s78 offen offset:0 sc1
    v_exp_f32 v99, v99
    v_exp_f32 v100, v100
    v_exp_f32 v101, v101
    v_exp_f32 v102, v102
    v_mfma_f32_32x32x16_bf16 v[80:95], v[20:23], v[16:19], v[64:79]
    ds_read_b128 v[20:23], v120 offset:14336
    v_exp_f32 v103, v103
    v_exp_f32 v104, v104
    v_exp_f32 v105, v105
    v_exp_f32 v106, v106
    v_exp_f32 v107, v107
    v_smfmac_f32_32x32x32_bf16 v[48:63], v[36:39], v[96:103], v122
    s_mov_b64 exec, s[70:71]
    ds_read_b128 v[36:39], v121 offset:12288
    ds_read_b128 v[40:43], v121 offset:13312
    s_mov_b64 exec, -1
    s_add_u32 m0, s81, 49152
    s_add_u32 s72, s14, 344064
    buffer_load_dwordx4 v123, s[48:51], s72 offen lds
    v_exp_f32 v108, v108
    v_exp_f32 v109, v109
    s_waitcnt vmcnt(21)
    v_mfma_f32_32x32x16_bf16 v[132:147], v[112:115], v[200:203], v[132:147]
    ds_read_b64_tr_b16 v[112:113], v126 offset:16384
    ds_read_b64_tr_b16 v[114:115], v126 offset:16896
    v_exp_f32 v110, v110
    v_mfma_f32_32x32x16_bf16 v[148:163], v[116:119], v[200:203], v[148:163]
    ds_read_b64_tr_b16 v[116:117], v126 offset:17408
    ds_read_b64_tr_b16 v[118:119], v126 offset:17920
    buffer_load_dwordx4 v[184:187], v3, s[44:47], s78 offen offset:1024 sc1
    v_exp_f32 v111, v111
    v_exp_f32 v80, v80
    v_exp_f32 v81, v81
    v_exp_f32 v82, v82
    v_smfmac_f32_32x32x32_bf16 v[48:63], v[44:47], v[104:111], v122
    s_setprio 1
    s_waitcnt lgkmcnt(0)
    buffer_load_dwordx4 v[188:191], v3, s[44:47], s78 offen offset:2048 sc1
    v_exp_f32 v83, v83
    v_exp_f32 v84, v84
    v_exp_f32 v85, v85
    v_exp_f32 v86, v86
    v_mfma_f32_32x32x16_bf16 v[96:111], v[20:23], v[16:19], v[64:79]
    ds_read_b128 v[20:23], v120 offset:24576
    v_exp_f32 v87, v87
    v_exp_f32 v88, v88
    v_exp_f32 v89, v89
    v_exp_f32 v90, v90
    v_exp_f32 v91, v91
    v_smfmac_f32_32x32x32_bf16 v[48:63], v[36:39], v[80:87], v122
    s_mov_b64 exec, s[70:71]
    ds_read_b128 v[36:39], v121 offset:14336
    ds_read_b128 v[44:47], v121 offset:15360
    s_mov_b64 exec, -1
    s_add_u32 m0, s81, 57344
    s_add_u32 s72, s14, 360448
    buffer_load_dwordx4 v123, s[48:51], s72 offen lds
    v_exp_f32 v92, v92
    v_exp_f32 v93, v93
    s_waitcnt vmcnt(23)
    v_mfma_f32_32x32x16_bf16 v[132:147], v[112:115], v[204:207], v[132:147]
    ds_read_b64_tr_b16 v[112:113], v126 offset:24576
    ds_read_b64_tr_b16 v[114:115], v126 offset:25088
    v_exp_f32 v94, v94
    v_mfma_f32_32x32x16_bf16 v[148:163], v[116:119], v[204:207], v[148:163]
    ds_read_b64_tr_b16 v[116:117], v126 offset:25600
    ds_read_b64_tr_b16 v[118:119], v126 offset:26112
    buffer_load_dwordx4 v[192:195], v3, s[44:47], s78 offen offset:3072 sc1
    v_exp_f32 v95, v95
    v_exp_f32 v96, v96
    v_exp_f32 v97, v97
    v_exp_f32 v98, v98
    v_smfmac_f32_32x32x32_bf16 v[48:63], v[40:43], v[88:95], v122
    s_setprio 0
    s_waitcnt lgkmcnt(0)
    v_exp_f32 v99, v99
    v_exp_f32 v100, v100
    v_exp_f32 v101, v101
    v_exp_f32 v102, v102
    v_mfma_f32_32x32x16_bf16 v[80:95], v[20:23], v[16:19], v[64:79]
    ds_read_b128 v[20:23], v120 offset:26624
    v_exp_f32 v103, v103
    v_exp_f32 v104, v104
    v_exp_f32 v105, v105
    v_exp_f32 v106, v106
    v_exp_f32 v107, v107
    v_smfmac_f32_32x32x32_bf16 v[48:63], v[36:39], v[96:103], v122
    s_mov_b64 exec, s[70:71]
    ds_read_b128 v[36:39], v121 offset:24576
    ds_read_b128 v[40:43], v121 offset:25600
    s_mov_b64 exec, -1
    s_add_u32 m0, s81, 99328
    s_add_u32 s72, s14, 376832
    buffer_load_dwordx4 v123, s[48:51], s72 offen lds
    v_exp_f32 v108, v108
    v_exp_f32 v109, v109
    s_waitcnt vmcnt(24)
    v_mfma_f32_32x32x16_bf16 v[132:147], v[112:115], v[208:211], v[132:147]
    ds_read_b64_tr_b16 v[112:113], v126 offset:32768
    ds_read_b64_tr_b16 v[114:115], v126 offset:33280
    v_exp_f32 v110, v110
    v_mfma_f32_32x32x16_bf16 v[148:163], v[116:119], v[208:211], v[148:163]
    ds_read_b64_tr_b16 v[116:117], v126 offset:33792
    ds_read_b64_tr_b16 v[118:119], v126 offset:34304
    v_exp_f32 v111, v111
    v_exp_f32 v80, v80
    v_exp_f32 v81, v81
    v_exp_f32 v82, v82
    v_smfmac_f32_32x32x32_bf16 v[48:63], v[44:47], v[104:111], v122
    s_waitcnt vmcnt(0) lgkmcnt(0)
    s_barrier
    s_setprio 3
    v_exp_f32 v83, v83
    v_exp_f32 v84, v84
    v_exp_f32 v85, v85
    v_exp_f32 v86, v86
    v_mfma_f32_32x32x16_bf16 v[96:111], v[20:23], v[16:19], v[64:79]
    ds_read_b128 v[20:23], v120 offset:28672
    v_exp_f32 v87, v87
    v_exp_f32 v88, v88
    v_exp_f32 v89, v89
    v_exp_f32 v90, v90
    v_exp_f32 v91, v91
    v_smfmac_f32_32x32x32_bf16 v[48:63], v[36:39], v[80:87], v122
    s_mov_b64 exec, s[70:71]
    ds_read_b128 v[36:39], v121 offset:26624
    ds_read_b128 v[44:47], v121 offset:27648
    s_mov_b64 exec, -1
    s_add_u32 m0, s81, 107520
    s_add_u32 s72, s14, 393216
    buffer_load_dwordx4 v123, s[48:51], s72 offen lds
    v_exp_f32 v92, v92
    v_exp_f32 v93, v93
    v_mfma_f32_32x32x16_bf16 v[132:147], v[112:115], v[212:215], v[132:147]
    ds_read_b64_tr_b16 v[112:113], v126 offset:40960
    ds_read_b64_tr_b16 v[114:115], v126 offset:41472
    v_exp_f32 v94, v94
    v_mfma_f32_32x32x16_bf16 v[148:163], v[116:119], v[212:215], v[148:163]
    ds_read_b64_tr_b16 v[116:117], v126 offset:41984
    ds_read_b64_tr_b16 v[118:119], v126 offset:42496
    v_exp_f32 v95, v95
    v_exp_f32 v96, v96
    v_exp_f32 v97, v97
    v_exp_f32 v98, v98
    v_smfmac_f32_32x32x32_bf16 v[48:63], v[40:43], v[88:95], v122
    s_setprio 2
    s_waitcnt lgkmcnt(0)
    v_exp_f32 v99, v99
    v_exp_f32 v100, v100
    v_exp_f32 v101, v101
    v_exp_f32 v102, v102
    v_mfma_f32_32x32x16_bf16 v[80:95], v[20:23], v[16:19], v[64:79]
    ds_read_b128 v[20:23], v120 offset:30720
    v_exp_f32 v103, v103
    v_exp_f32 v104, v104
    v_exp_f32 v105, v105
    v_exp_f32 v106, v106
    v_exp_f32 v107, v107
    v_smfmac_f32_32x32x32_bf16 v[48:63], v[36:39], v[96:103], v122
    s_mov_b64 exec, s[70:71]
    ds_read_b128 v[36:39], v121 offset:28672
    ds_read_b128 v[40:43], v121 offset:29696
    s_mov_b64 exec, -1
    s_add_u32 m0, s81, 115712
    s_add_u32 s72, s14, 409600
    buffer_load_dwordx4 v123, s[48:51], s72 offen lds
    v_exp_f32 v108, v108
    v_exp_f32 v109, v109
    v_mfma_f32_32x32x16_bf16 v[132:147], v[112:115], v[216:219], v[132:147]
    v_exp_f32 v110, v110
    v_mfma_f32_32x32x16_bf16 v[148:163], v[116:119], v[216:219], v[148:163]
    v_exp_f32 v111, v111
    v_exp_f32 v80, v80
    v_exp_f32 v81, v81
    v_exp_f32 v82, v82
    v_smfmac_f32_32x32x32_bf16 v[48:63], v[44:47], v[104:111], v122
    s_setprio 1
    s_waitcnt lgkmcnt(0)
    v_exp_f32 v83, v83
    v_exp_f32 v84, v84
    v_exp_f32 v85, v85
    v_exp_f32 v86, v86
    v_mfma_f32_32x32x16_bf16 v[96:111], v[20:23], v[16:19], v[64:79]
    v_exp_f32 v87, v87
    v_exp_f32 v88, v88
    v_exp_f32 v89, v89
    v_exp_f32 v90, v90
    v_exp_f32 v91, v91
    v_smfmac_f32_32x32x32_bf16 v[48:63], v[36:39], v[80:87], v122
    s_mov_b64 exec, s[70:71]
    ds_read_b128 v[36:39], v121 offset:30720
    ds_read_b128 v[44:47], v121 offset:31744
    s_mov_b64 exec, -1
    s_add_u32 m0, s81, 123904
    s_add_u32 s72, s14, 425984
    buffer_load_dwordx4 v123, s[48:51], s72 offen lds
    v_exp_f32 v92, v92
    v_exp_f32 v93, v93
    v_exp_f32 v94, v94
    v_exp_f32 v95, v95
    v_exp_f32 v96, v96
    v_exp_f32 v97, v97
    v_exp_f32 v98, v98
    v_smfmac_f32_32x32x32_bf16 v[48:63], v[40:43], v[88:95], v122
    s_setprio 0
    s_waitcnt lgkmcnt(0)
    v_exp_f32 v99, v99
    v_exp_f32 v100, v100
    v_exp_f32 v101, v101
    v_exp_f32 v102, v102
    v_exp_f32 v103, v103
    v_exp_f32 v104, v104
    v_exp_f32 v105, v105
    v_exp_f32 v106, v106
    v_exp_f32 v107, v107
    v_smfmac_f32_32x32x32_bf16 v[48:63], v[36:39], v[96:103], v122
    s_add_u32 m0, s81, 132096
    s_add_u32 s72, s14, 442368
    buffer_load_dwordx4 v123, s[48:51], s72 offen lds
    v_exp_f32 v108, v108
    v_exp_f32 v109, v109
    v_exp_f32 v110, v110
    v_exp_f32 v111, v111
    buffer_load_dwordx4 v[24:27], v128, s[32:35], s15 offen
    s_nop 0
    v_smfmac_f32_32x32x32_bf16 v[48:63], v[44:47], v[104:111], v122
    s_nop 2
    v_mov_b32 v30, 0x79000000
    v_mov_b32 v31, 0x7e800000
    s_nop 6
    v_add_f32 v28, |v48|, |v49|
    v_add_f32 v28, v28, |v50|
    v_add_f32 v28, v28, |v51|
    v_add_f32 v28, v28, |v52|
    v_add_f32 v28, v28, |v53|
    v_add_f32 v28, v28, |v54|
    v_add_f32 v28, v28, |v55|
    v_cmp_lt_f32 vcc, v56, v30
    v_cmp_lt_f32 s[72:73], v28, v31
    v_mov_b32 v30, 0xa800000
    v_cmp_gt_f32 s[74:75], v28, v30
    s_nop 3
    s_and_b64 vcc, vcc, s[72:73]
    s_and_b64 vcc, vcc, s[74:75]
    s_cmp_eq_u64 vcc, -1
    s_cbranch_scc0 FBK_44
ON_45:
    v_rcp_f32 v29, v56
    s_nop 0
    v_mul_f32 v48, v48, v29
    v_mul_f32 v49, v49, v29
    v_mul_f32 v50, v50, v29
    v_mul_f32 v51, v51, v29
    v_mul_f32 v52, v52, v29
    v_mul_f32 v53, v53, v29
    v_mul_f32 v54, v54, v29
    v_mul_f32 v55, v55, v29
    v_cvt_pk_bf16_f32 v48, v48, v49
    v_cvt_pk_bf16_f32 v49, v50, v51
    v_cvt_pk_bf16_f32 v50, v52, v53
    v_cvt_pk_bf16_f32 v51, v54, v55
    buffer_store_dwordx4 v[48:51], v3, s[44:47], s22 offen sc1
    ds_read_b64_tr_b16 v[96:97], v126 offset:49152
    ds_read_b64_tr_b16 v[98:99], v126 offset:49664
    ds_read_b64_tr_b16 v[100:101], v126 offset:50176
    ds_read_b64_tr_b16 v[102:103], v126 offset:50688
    ds_read_b64_tr_b16 v[80:81], v124 offset:0
    ds_read_b64_tr_b16 v[82:83], v124 offset:512
    ds_read_b64_tr_b16 v[84:85], v124 offset:1024
    ds_read_b64_tr_b16 v[86:87], v124 offset:1536
    ds_read_b64_tr_b16 v[88:89], v124 offset:8192
    ds_read_b64_tr_b16 v[90:91], v124 offset:8704
    ds_read_b64_tr_b16 v[92:93], v124 offset:9216
    ds_read_b64_tr_b16 v[94:95], v124 offset:9728
    s_waitcnt lgkmcnt(8)
    v_mfma_f32_32x32x16_bf16 v[132:147], v[96:99], v[220:223], v[132:147]
    v_mfma_f32_32x32x16_bf16 v[148:163], v[100:103], v[220:223], v[148:163]
    s_barrier
    ds_read_b64_tr_b16 v[96:97], v124 offset:16384
    ds_read_b64_tr_b16 v[98:99], v124 offset:16896
    ds_read_b64_tr_b16 v[100:101], v124 offset:17408
    ds_read_b64_tr_b16 v[102:103], v124 offset:17920
    s_waitcnt lgkmcnt(8)
    v_mfma_f32_32x32x16_bf16 v[132:147], v[80:83], v[224:227], v[132:147]
    s_add_u32 m0, s81, 140288
    s_lshl_b32 s72, s31, 17
    s_add_u32 s72, s72, 0
    buffer_load_dwordx4 v123, s[52:55], s72 offen lds
    s_add_u32 m0, s81, 148480
    s_lshl_b32 s72, s31, 17
    s_add_u32 s72, s72, 16384
    buffer_load_dwordx4 v123, s[52:55], s72 offen lds
    v_mfma_f32_32x32x16_bf16 v[148:163], v[84:87], v[224:227], v[148:163]
    s_add_u32 m0, s81, 66560
    s_lshl_b32 s72, s31, 17
    s_add_u32 s72, s72, 32768
    buffer_load_dwordx4 v123, s[52:55], s72 offen lds
    s_add_u32 m0, s81, 74752
    s_lshl_b32 s72, s31, 17
    s_add_u32 s72, s72, 49152
    buffer_load_dwordx4 v123, s[52:55], s72 offen lds
    ds_read_b64_tr_b16 v[80:81], v124 offset:24576
    ds_read_b64_tr_b16 v[82:83], v124 offset:25088
    ds_read_b64_tr_b16 v[84:85], v124 offset:25600
    ds_read_b64_tr_b16 v[86:87], v124 offset:26112
    s_waitcnt lgkmcnt(8)
    v_mfma_f32_32x32x16_bf16 v[132:147], v[88:91], v[228:231], v[132:147]
    s_add_u32 m0, s81, 82944
    s_lshl_b32 s72, s31, 17
    s_add_u32 s72, s72, 65536
    buffer_load_dwordx4 v123, s[52:55], s72 offen lds
    s_add_u32 m0, s81, 91136
    s_lshl_b32 s72, s31, 17
    s_add_u32 s72, s72, 81920
    buffer_load_dwordx4 v123, s[52:55], s72 offen lds
    v_mfma_f32_32x32x16_bf16 v[148:163], v[92:95], v[228:231], v[148:163]
    ds_read_b64_tr_b16 v[88:89], v124 offset:32768
    ds_read_b64_tr_b16 v[90:91], v124 offset:33280
    ds_read_b64_tr_b16 v[92:93], v124 offset:33792
    ds_read_b64_tr_b16 v[94:95], v124 offset:34304
    s_waitcnt lgkmcnt(8)
    v_mfma_f32_32x32x16_bf16 v[132:147], v[96:99], v[232:235], v[132:147]
    v_mfma_f32_32x32x16_bf16 v[148:163], v[100:103], v[232:235], v[148:163]
    ds_read_b64_tr_b16 v[96:97], v124 offset:40960
    ds_read_b64_tr_b16 v[98:99], v124 offset:41472
    ds_read_b64_tr_b16 v[100:101], v124 offset:41984
    ds_read_b64_tr_b16 v[102:103], v124 offset:42496
    s_waitcnt lgkmcnt(8)
    v_mfma_f32_32x32x16_bf16 v[132:147], v[80:83], v[236:239], v[132:147]
    v_mfma_f32_32x32x16_bf16 v[148:163], v[84:87], v[236:239], v[148:163]
    ds_read_b64_tr_b16 v[80:81], v124 offset:49152
    ds_read_b64_tr_b16 v[82:83], v124 offset:49664
    ds_read_b64_tr_b16 v[84:85], v124 offset:50176
    ds_read_b64_tr_b16 v[86:87], v124 offset:50688
    s_waitcnt lgkmcnt(8)
    v_mfma_f32_32x32x16_bf16 v[132:147], v[88:91], v[240:243], v[132:147]
    v_mfma_f32_32x32x16_bf16 v[148:163], v[92:95], v[240:243], v[148:163]
    ds_read_b64_tr_b16 v[88:89], v124 offset:57344
    ds_read_b64_tr_b16 v[90:91], v124 offset:57856
    ds_read_b64_tr_b16 v[92:93], v124 offset:58368
    ds_read_b64_tr_b16 v[94:95], v124 offset:58880
    s_waitcnt lgkmcnt(8)
    v_mfma_f32_32x32x16_bf16 v[132:147], v[96:99], v[164:167], v[132:147]
    v_mfma_f32_32x32x16_bf16 v[148:163], v[100:103], v[164:167], v[148:163]
    ds_read_b64_tr_b16 v[96:97], v126 offset:0
    ds_read_b64_tr_b16 v[98:99], v126 offset:512
    ds_read_b64_tr_b16 v[100:101], v126 offset:1024
    ds_read_b64_tr_b16 v[102:103], v126 offset:1536
    s_waitcnt lgkmcnt(8)
    v_mfma_f32_32x32x16_bf16 v[132:147], v[80:83], v[168:171], v[132:147]
    v_mfma_f32_32x32x16_bf16 v[148:163], v[84:87], v[168:171], v[148:163]
    s_waitcnt vmcnt(8)
    s_barrier
    ds_read_b64_tr_b16 v[80:81], v126 offset:8192
    ds_read_b64_tr_b16 v[82:83], v126 offset:8704
    ds_read_b64_tr_b16 v[84:85], v126 offset:9216
    ds_read_b64_tr_b16 v[86:87], v126 offset:9728
    s_waitcnt lgkmcnt(8)
    v_mfma_f32_32x32x16_bf16 v[132:147], v[88:91], v[172:175], v[132:147]
    s_add_u32 m0, s81, 0
    s_lshl_b32 s72, s31, 17
    s_add_u32 s72, s72, 98304
    buffer_load_dwordx4 v123, s[52:55], s72 offen lds
    s_add_u32 m0, s81, 8192
    s_lshl_b32 s72, s31, 17
    s_add_u32 s72, s72, 114688
    buffer_load_dwordx4 v123, s[52:55], s72 offen lds
    v_mfma_f32_32x32x16_bf16 v[148:163], v[92:95], v[172:175], v[148:163]
    ds_read_b64_tr_b16 v[88:89], v126 offset:16384
    ds_read_b64_tr_b16 v[90:91], v126 offset:16896
    ds_read_b64_tr_b16 v[92:93], v126 offset:17408
    ds_read_b64_tr_b16 v[94:95], v126 offset:17920
    s_waitcnt lgkmcnt(8)
    v_mfma_f32_32x32x16_bf16 v[132:147], v[96:99], v[176:179], v[132:147]
    v_mfma_f32_32x32x16_bf16 v[148:163], v[100:103], v[176:179], v[148:163]
    ds_read_b64_tr_b16 v[96:97], v126 offset:24576
    ds_read_b64_tr_b16 v[98:99], v126 offset:25088
    ds_read_b64_tr_b16 v[100:101], v126 offset:25600
    ds_read_b64_tr_b16 v[102:103], v126 offset:26112
    s_waitcnt lgkmcnt(8)
    v_mfma_f32_32x32x16_bf16 v[132:147], v[80:83], v[180:183], v[132:147]
    v_mfma_f32_32x32x16_bf16 v[148:163], v[84:87], v[180:183], v[148:163]
    s_lshl_b32 s74, s31, 13
    s_add_u32 s74, s74, s79
    s_add_u32 s75, s74, 4096
    buffer_load_dwordx4 v[36:39], v3, s[44:47], s74 offen offset:0 sc1
    buffer_load_dwordx4 v[40:43], v3, s[44:47], s74 offen offset:1024 sc1
    buffer_load_dwordx4 v[44:47], v3, s[44:47], s74 offen offset:2048 sc1
    buffer_load_dwordx4 v[52:55], v3, s[44:47], s74 offen offset:3072 sc1
    buffer_load_dwordx4 v[56:59], v3, s[44:47], s75 offen offset:0 sc1
    buffer_load_dwordx4 v[60:63], v3, s[44:47], s75 offen offset:1024 sc1
    buffer_load_dwordx4 v[64:67], v3, s[44:47], s75 offen offset:2048 sc1
    buffer_load_dwordx4 v[68:71], v3, s[44:47], s75 offen offset:3072 sc1
    ds_read_b64_tr_b16 v[80:81], v126 offset:32768
    ds_read_b64_tr_b16 v[82:83], v126 offset:33280
    ds_read_b64_tr_b16 v[84:85], v126 offset:33792
    ds_read_b64_tr_b16 v[86:87], v126 offset:34304
    s_waitcnt lgkmcnt(8)
    v_mfma_f32_32x32x16_bf16 v[132:147], v[88:91], v[184:187], v[132:147]
    v_mfma_f32_32x32x16_bf16 v[148:163], v[92:95], v[184:187], v[148:163]
    s_waitcnt vmcnt(8)
    s_barrier
    s_waitcnt lgkmcnt(4)
    v_mfma_f32_32x32x16_bf16 v[132:147], v[96:99], v[188:191], v[132:147]
    v_mfma_f32_32x32x16_bf16 v[148:163], v[100:103], v[188:191], v[148:163]
    s_waitcnt lgkmcnt(0)
    v_mfma_f32_32x32x16_bf16 v[132:147], v[80:83], v[192:195], v[132:147]
    v_mfma_f32_32x32x16_bf16 v[148:163], v[84:87], v[192:195], v[148:163]
    ds_read_b64_tr_b16 v[72:73], v126 offset:40960
    ds_read_b64_tr_b16 v[74:75], v126 offset:41472
    ds_read_b64_tr_b16 v[76:77], v126 offset:49152
    ds_read_b64_tr_b16 v[78:79], v126 offset:49664
    ds_read_b64_tr_b16 v[80:81], v125 offset:0
    ds_read_b64_tr_b16 v[82:83], v125 offset:512
    ds_read_b64_tr_b16 v[84:85], v125 offset:8192
    ds_read_b64_tr_b16 v[86:87], v125 offset:8704
    ds_read_b64_tr_b16 v[88:89], v125 offset:16384
    ds_read_b64_tr_b16 v[90:91], v125 offset:16896
    s_waitcnt vmcnt(0)
    s_mov_b32 s80, 0
OL_47:
    v_max3_u32 v28, v36, v37, v38
    v_max3_u32 v29, v39, v40, v41
    v_max3_u32 v29, v29, v42, v43
    v_max3_u32 v28, v28, v44, v45
    v_max3_u32 v29, v29, v46, v47
    v_max3_u32 v28, v28, v52, v53
    v_max3_u32 v29, v29, v54, v55
    v_max3_u32 v28, v28, v56, v57
    v_max3_u32 v29, v29, v58, v59
    v_max3_u32 v28, v28, v60, v61
    v_max3_u32 v29, v29, v62, v63
    v_max3_u32 v28, v28, v64, v65
    v_max3_u32 v29, v29, v66, v67
    v_max3_u32 v28, v28, v68, v69
    v_max3_u32 v29, v29, v70, v71
    v_max_u32 v28, v28, v29
    v_cmp_eq_u32 vcc, -1, v28
    s_nop 4
    s_cbranch_vccz OD_46
    s_add_u32 s80, s80, 1
    s_cmp_gt_u32 s80, 200000
    s_cbranch_scc1 OD_46
    s_sleep 4
    buffer_load_dwordx4 v[36:39], v3, s[44:47], s74 offen offset:0 sc1
    buffer_load_dwordx4 v[40:43], v3, s[44:47], s74 offen offset:1024 sc1
    buffer_load_dwordx4 v[44:47], v3, s[44:47], s74 offen offset:2048 sc1
    buffer_load_dwordx4 v[52:55], v3, s[44:47], s74 offen offset:3072 sc1
    buffer_load_dwordx4 v[56:59], v3, s[44:47], s75 offen offset:0 sc1
    buffer_load_dwordx4 v[60:63], v3, s[44:47], s75 offen offset:1024 sc1
    buffer_load_dwordx4 v[64:67], v3, s[44:47], s75 offen offset:2048 sc1
    buffer_load_dwordx4 v[68:71], v3, s[44:47], s75 offen offset:3072 sc1
    s_waitcnt vmcnt(0)
    s_branch OL_47
OD_46:
    v_add_u32 v28, 66560, v129
    v_add_u32 v29, 99328, v129
    v_lshlrev_b32 v16, 16, v24
    v_and_b32 v17, 0xffff0000, v24
    v_lshlrev_b32 v18, 16, v25
    v_and_b32 v19, 0xffff0000, v25
    v_lshlrev_b32 v20, 16, v26
    v_and_b32 v21, 0xffff0000, v26
    v_lshlrev_b32 v22, 16, v27
    v_and_b32 v23, 0xffff0000, v27
    s_waitcnt lgkmcnt(8)
    v_mfma_f32_32x32x16_bf16 v[132:147], v[72:75], v[36:39], v[132:147]
    ds_read_b64_tr_b16 v[92:93], v125 offset:24576
    ds_read_b64_tr_b16 v[94:95], v125 offset:25088
    s_waitcnt lgkmcnt(8)
    v_mfma_f32_32x32x16_bf16 v[132:147], v[76:79], v[40:43], v[132:147]
    ds_read_b64_tr_b16 v[72:73], v124 offset:0
    ds_read_b64_tr_b16 v[74:75], v124 offset:512
    s_waitcnt lgkmcnt(8)
    v_mfma_f32_32x32x16_bf16 v[132:147], v[80:83], v[44:47], v[132:147]
    ds_read_b64_tr_b16 v[76:77], v124 offset:8192
    ds_read_b64_tr_b16 v[78:79], v124 offset:8704
    s_waitcnt lgkmcnt(8)
    v_mfma_f32_32x32x16_bf16 v[132:147], v[84:87], v[52:55], v[132:147]
    ds_read_b64_tr_b16 v[80:81], v126 offset:41984
    ds_read_b64_tr_b16 v[82:83], v126 offset:42496
    s_waitcnt lgkmcnt(8)
    v_mfma_f32_32x32x16_bf16 v[132:147], v[88:91], v[56:59], v[132:147]
    ds_read_b64_tr_b16 v[84:85], v126 offset:50176
    ds_read_b64_tr_b16 v[86:87], v126 offset:50688
    s_waitcnt lgkmcnt(8)
    v_mfma_f32_32x32x16_bf16 v[132:147], v[92:95], v[60:63], v[132:147]
    ds_read_b64_tr_b16 v[88:89], v125 offset:1024
    ds_read_b64_tr_b16 v[90:91], v125 offset:1536
    s_waitcnt lgkmcnt(8)
    v_mfma_f32_32x32x16_bf16 v[132:147], v[72:75], v[64:67], v[132:147]
    ds_read_b64_tr_b16 v[92:93], v125 offset:9216
    ds_read_b64_tr_b16 v[94:95], v125 offset:9728
    s_waitcnt lgkmcnt(8)
    v_mfma_f32_32x32x16_bf16 v[132:147], v[76:79], v[68:71], v[132:147]
    ds_read_b64_tr_b16 v[72:73], v125 offset:17408
    ds_read_b64_tr_b16 v[74:75], v125 offset:17920
    s_waitcnt lgkmcnt(8)
    v_mfma_f32_32x32x16_bf16 v[148:163], v[80:83], v[36:39], v[148:163]
    ds_read_b64_tr_b16 v[76:77], v125 offset:25600
    ds_read_b64_tr_b16 v[78:79], v125 offset:26112
    s_waitcnt lgkmcnt(8)
    v_mfma_f32_32x32x16_bf16 v[148:163], v[84:87], v[40:43], v[148:163]
    ds_read_b64_tr_b16 v[80:81], v124 offset:1024
    ds_read_b64_tr_b16 v[82:83], v124 offset:1536
    s_waitcnt lgkmcnt(8)
    v_mfma_f32_32x32x16_bf16 v[148:163], v[88:91], v[44:47], v[148:163]
    ds_read_b64_tr_b16 v[84:85], v124 offset:9216
    ds_read_b64_tr_b16 v[86:87], v124 offset:9728
    s_cmp_lg_u32 s31, 0
    s_cbranch_scc1 FK_49
    s_waitcnt lgkmcnt(8)
    v_mfma_f32_32x32x16_bf16 v[148:163], v[92:95], v[52:55], v[148:163]
    ds_write_b128 v129, v[140:143] offset:36864
    s_waitcnt lgkmcnt(7)
    v_mfma_f32_32x32x16_bf16 v[148:163], v[72:75], v[56:59], v[148:163]
    ds_write_b128 v129, v[144:147] offset:37888
    s_waitcnt lgkmcnt(6)
    v_mfma_f32_32x32x16_bf16 v[148:163], v[76:79], v[60:63], v[148:163]
    s_waitcnt lgkmcnt(4)
    v_mfma_f32_32x32x16_bf16 v[148:163], v[80:83], v[64:67], v[148:163]
    s_waitcnt lgkmcnt(2)
    v_mfma_f32_32x32x16_bf16 v[148:163], v[84:87], v[68:71], v[148:163]
    s_nop 7
    s_nop 3
    ds_write_b128 v129, v[148:151] offset:45056
    ds_write_b128 v129, v[152:155] offset:46080
    ds_write_b128 v129, v[156:159] offset:53248
    ds_write_b128 v129, v[160:163] offset:54272
    v_mov_b32 v104, v132
    v_mov_b32 v105, v133
    v_mov_b32 v106, v134
    v_mov_b32 v107, v135
    v_mov_b32 v108, v136
    v_mov_b32 v109, v137
    v_mov_b32 v110, v138
    v_mov_b32 v111, v139
    s_waitcnt lgkmcnt(0)
    s_barrier
    ds_read_b128 v[64:67], v129 offset:16384
    ds_read_b128 v[68:71], v129 offset:17408
    ds_read_b128 v[72:75], v129 offset:20480
    ds_read_b128 v[76:79], v129 offset:21504
    ds_read_b128 v[80:83], v129 offset:24576
    ds_read_b128 v[84:87], v129 offset:25600
    s_branch FIN_48
FK_49:
    s_cmp_lg_u32 s31, 1
    s_cbranch_scc1 FK_50
    s_waitcnt lgkmcnt(8)
    v_mfma_f32_32x32x16_bf16 v[148:163], v[92:95], v[52:55], v[148:163]
    ds_write_b128 v129, v[132:135] offset:16384
    s_waitcnt lgkmcnt(7)
    v_mfma_f32_32x32x16_bf16 v[148:163], v[72:75], v[56:59], v[148:163]
    ds_write_b128 v129, v[136:139] offset:17408
    s_waitcnt lgkmcnt(6)
    v_mfma_f32_32x32x16_bf16 v[148:163], v[76:79], v[60:63], v[148:163]
    s_waitcnt lgkmcnt(4)
    v_mfma_f32_32x32x16_bf16 v[148:163], v[80:83], v[64:67], v[148:163]
    s_waitcnt lgkmcnt(2)
    v_mfma_f32_32x32x16_bf16 v[148:163], v[84:87], v[68:71], v[148:163]
    s_nop 7
    s_nop 3
    ds_write_b128 v129, v[148:151] offset:49152
    ds_write_b128 v129, v[152:155] offset:50176
    ds_write_b128 v129, v[156:159] offset:57344
    ds_write_b128 v129, v[160:163] offset:58368
    v_mov_b32 v104, v140
    v_mov_b32 v105, v141
    v_mov_b32 v106, v142
    v_mov_b32 v107, v143
    v_mov_b32 v108, v144
    v_mov_b32 v109, v145
    v_mov_b32 v110, v146
    v_mov_b32 v111, v147
    s_waitcnt lgkmcnt(0)
    s_barrier
    ds_read_b128 v[64:67], v129 offset:28672
    ds_read_b128 v[68:71], v129 offset:29696
    ds_read_b128 v[72:75], v129 offset:32768
    ds_read_b128 v[76:79], v129 offset:33792
    ds_read_b128 v[80:83], v129 offset:36864
    ds_read_b128 v[84:87], v129 offset:37888
    s_branch FIN_48
FK_50:
    s_cmp_lg_u32 s31, 2
    s_cbranch_scc1 FK_51
    s_waitcnt lgkmcnt(8)
    v_mfma_f32_32x32x16_bf16 v[148:163], v[92:95], v[52:55], v[148:163]
    ds_write_b128 v129, v[132:135] offset:20480
    s_waitcnt lgkmcnt(7)
    v_mfma_f32_32x32x16_bf16 v[148:163], v[72:75], v[56:59], v[148:163]
    ds_write_b128 v129, v[136:139] offset:21504
    s_waitcnt lgkmcnt(6)
    v_mfma_f32_32x32x16_bf16 v[148:163], v[76:79], v[60:63], v[148:163]
    ds_write_b128 v129, v[140:143] offset:28672
    s_waitcnt lgkmcnt(5)
    v_mfma_f32_32x32x16_bf16 v[148:163], v[80:83], v[64:67], v[148:163]
    ds_write_b128 v129, v[144:147] offset:29696
    s_waitcnt lgkmcnt(4)
    v_mfma_f32_32x32x16_bf16 v[148:163], v[84:87], v[68:71], v[148:163]
    s_nop 7
    s_nop 3
    ds_write_b128 v129, v[156:159] offset:61440
    ds_write_b128 v129, v[160:163] offset:62464
    v_mov_b32 v104, v148
    v_mov_b32 v105, v149
    v_mov_b32 v106, v150
    v_mov_b32 v107, v151
    v_mov_b32 v108, v152
    v_mov_b32 v109, v153
    v_mov_b32 v110, v154
    v_mov_b32 v111, v155
    s_waitcnt lgkmcnt(0)
    s_barrier
    ds_read_b128 v[64:67], v129 offset:40960
    ds_read_b128 v[68:71], v129 offset:41984
    ds_read_b128 v[72:75], v129 offset:45056
    ds_read_b128 v[76:79], v129 offset:46080
    ds_read_b128 v[80:83], v129 offset:49152
    ds_read_b128 v[84:87], v129 offset:50176
    s_branch FIN_48
FK_51:
    s_waitcnt lgkmcnt(8)
    v_mfma_f32_32x32x16_bf16 v[148:163], v[92:95], v[52:55], v[148:163]
    ds_write_b128 v129, v[132:135] offset:24576
    s_waitcnt lgkmcnt(7)
    v_mfma_f32_32x32x16_bf16 v[148:163], v[72:75], v[56:59], v[148:163]
    ds_write_b128 v129, v[136:139] offset:25600
    s_waitcnt lgkmcnt(6)
    v_mfma_f32_32x32x16_bf16 v[148:163], v[76:79], v[60:63], v[148:163]
    ds_write_b128 v129, v[140:143] offset:32768
    s_waitcnt lgkmcnt(5)
    v_mfma_f32_32x32x16_bf16 v[148:163], v[80:83], v[64:67], v[148:163]
    ds_write_b128 v129, v[144:147] offset:33792
    s_waitcnt lgkmcnt(4)
    v_mfma_f32_32x32x16_bf16 v[148:163], v[84:87], v[68:71], v[148:163]
    s_nop 7
    s_nop 3
    ds_write_b128 v129, v[148:151] offset:40960
    ds_write_b128 v129, v[152:155] offset:41984
    v_mov_b32 v104, v156
    v_mov_b32 v105, v157
    v_mov_b32 v106, v158
    v_mov_b32 v107, v159
    v_mov_b32 v108, v160
    v_mov_b32 v109, v161
    v_mov_b32 v110, v162
    v_mov_b32 v111, v163
    s_waitcnt lgkmcnt(0)
    s_barrier
    ds_read_b128 v[64:67], v129 offset:53248
    ds_read_b128 v[68:71], v129 offset:54272
    ds_read_b128 v[72:75], v129 offset:57344
    ds_read_b128 v[76:79], v129 offset:58368
    ds_read_b128 v[80:83], v129 offset:61440
    ds_read_b128 v[84:87], v129 offset:62464
FIN_48:
    s_waitcnt lgkmcnt(4)
    v_pk_add_f32 v[104:105], v[104:105], v[64:65]
    v_pk_add_f32 v[106:107], v[106:107], v[66:67]
    v_pk_add_f32 v[108:109], v[108:109], v[68:69]
    v_pk_add_f32 v[110:111], v[110:111], v[70:71]
    s_waitcnt lgkmcnt(2)
    v_pk_add_f32 v[104:105], v[104:105], v[72:73]
    v_pk_add_f32 v[106:107], v[106:107], v[74:75]
    v_pk_add_f32 v[108:109], v[108:109], v[76:77]
    v_pk_add_f32 v[110:111], v[110:111], v[78:79]
    s_waitcnt lgkmcnt(0)
    v_pk_add_f32 v[104:105], v[104:105], v[80:81]
    v_pk_add_f32 v[106:107], v[106:107], v[82:83]
    v_pk_add_f32 v[108:109], v[108:109], v[84:85]
    v_pk_add_f32 v[110:111], v[110:111], v[86:87]
    s_nop 1
    v_permlane32_swap_b32 v104, v108
    v_permlane32_swap_b32 v105, v109
    v_permlane32_swap_b32 v106, v110
    v_permlane32_swap_b32 v107, v111
    s_nop 1
    v_pk_add_f32 v[104:105], v[104:105], v[16:17]
    v_pk_add_f32 v[106:107], v[106:107], v[18:19]
    v_pk_add_f32 v[108:109], v[108:109], v[20:21]
    v_pk_add_f32 v[110:111], v[110:111], v[22:23]
    v_cvt_pk_bf16_f32 v104, v104, v105
    v_cvt_pk_bf16_f32 v105, v106, v107
    v_cvt_pk_bf16_f32 v106, v108, v109
    v_cvt_pk_bf16_f32 v107, v110, v111
    buffer_store_dwordx4 v[104:107], v128, s[56:59], s15 offen
    s_or_b32 s72, s26, s27
    s_or_b32 s72, s72, s28
    s_cmp_lg_u32 s72, 0
    s_cbranch_scc1 EP_53
    v_mov_b32 v29, s29
    s_mov_b64 exec, 1
    buffer_store_dword v29, off, s[44:47], 0 offset:0
    s_mov_b64 exec, -1
EP_53:
    s_endpgm
FBK_44:
    v_subrev_u32 v30, 66560, v120
    v_subrev_u32 v29, 66560, v121
    s_mov_b32 s74, 65536
    v_mov_b32 v28, 0xff800000
FL_54:
    buffer_load_dwordx4 v[20:23], v30, s[44:47], s74 offen sc1
    s_waitcnt vmcnt(0)
    v_mfma_f32_32x32x16_bf16 v[80:95], v[20:23], v[16:19], 0
    s_nop 7
    s_nop 3
    v_max3_f32 v28, v28, v80, v81
    v_max3_f32 v28, v28, v82, v83
    v_max3_f32 v28, v28, v84, v85
    v_max3_f32 v28, v28, v86, v87
    v_max3_f32 v28, v28, v88, v89
    v_max3_f32 v28, v28, v90, v91
    v_max3_f32 v28, v28, v92, v93
    v_max3_f32 v28, v28, v94, v95
    s_add_u32 s74, s74, 2048
    s_cmp_lt_u32 s74, 196608
    s_cbranch_scc1 FL_54
    v_mov_b32 v31, v28
    s_nop 1
    v_permlane32_swap_b32 v31, v28
    s_nop 1
    v_max_f32 v28, v28, v31
    v_add_f32 v28, 0x0, v28
    v_xor_b32 v64, 0x80000000, v28
    v_mov_b32 v65, v64
    v_mov_b32 v66, v64
    v_mov_b32 v67, v64
    v_mov_b32 v68, v64
    v_mov_b32 v69, v64
    v_mov_b32 v70, v64
    v_mov_b32 v71, v64
    v_mov_b32 v72, v64
    v_mov_b32 v73, v64
    v_mov_b32 v74, v64
    v_mov_b32 v75, v64
    v_mov_b32 v76, v64
    v_mov_b32 v77, v64
    v_mov_b32 v78, v64
    v_mov_b32 v79, v64
    v_mov_b32 v48, 0
    v_mov_b32 v49, 0
    v_mov_b32 v50, 0
    v_mov_b32 v51, 0
    v_mov_b32 v52, 0
    v_mov_b32 v53, 0
    v_mov_b32 v54, 0
    v_mov_b32 v55, 0
    v_mov_b32 v56, 0
    v_mov_b32 v57, 0
    v_mov_b32 v58, 0
    v_mov_b32 v59, 0
    v_mov_b32 v60, 0
    v_mov_b32 v61, 0
    v_mov_b32 v62, 0
    v_mov_b32 v63, 0
    s_mov_b32 s74, 65536
FL_55:
    buffer_load_dwordx4 v[20:23], v30, s[44:47], s74 offen sc1
    s_mov_b64 exec, s[70:71]
    buffer_load_dwordx4 v[36:39], v29, s[44:47], s74 offen sc1
    buffer_load_dwordx4 v[40:43], v29, s[44:47], s74 offen offset:1024 sc1
    s_mov_b64 exec, -1
    s_waitcnt vmcnt(0)
    v_mfma_f32_32x32x16_bf16 v[80:95], v[20:23], v[16:19], v[64:79]
    s_nop 7
    s_nop 3
    v_exp_f32 v80, v80
    v_exp_f32 v81, v81
    v_exp_f32 v82, v82
    v_exp_f32 v83, v83
    v_exp_f32 v84, v84
    v_exp_f32 v85, v85
    v_exp_f32 v86, v86
    v_exp_f32 v87, v87
    v_exp_f32 v88, v88
    v_exp_f32 v89, v89
    v_exp_f32 v90, v90
    v_exp_f32 v91, v91
    v_exp_f32 v92, v92
    v_exp_f32 v93, v93
    v_exp_f32 v94, v94
    v_exp_f32 v95, v95
    s_nop 1
    v_smfmac_f32_32x32x32_bf16 v[48:63], v[36:39], v[80:87], v122
    v_smfmac_f32_32x32x32_bf16 v[48:63], v[40:43], v[88:95], v122
    s_add_u32 s74, s74, 2048
    s_cmp_lt_u32 s74, 196608
    s_cbranch_scc1 FL_55
    s_nop 7
    s_nop 3
    s_branch ON_45
L_END:
    s_endpgm
.section .rodata,"a"
.p2align 6
.amdhsa_kernel parallel_sum__grouped_kv_mqa__dense_activation_relu__prompt_kernel
  .amdhsa_next_free_vgpr 256
  .amdhsa_next_free_sgpr 102
  .amdhsa_accum_offset 256
  .amdhsa_group_segment_fixed_size 0
  .amdhsa_kernarg_size 88
  .amdhsa_user_sgpr_count 2
  .amdhsa_user_sgpr_kernarg_segment_ptr 1
  .amdhsa_system_sgpr_workgroup_id_x 1
.end_amdhsa_kernel
```
